```python
import torch

def _softmax(x, axis=-1):
    return torch.softmax(x, dim=axis)
def _gelu(x):
    return torch.nn.functional.gelu(x, approximate="tanh")
def _silu(x):
    return torch.nn.functional.silu(x)
def _sigmoid(x):
    return torch.sigmoid(x)
def _layernorm(x, axis=-1, eps=1e-5):
    m = x.mean(dim=axis, keepdim=True)
    v = x.var(dim=axis, keepdim=True, unbiased=False)
    return (x - m) / torch.sqrt(v + eps)
def _scatter_add(tgt, idx, src, axis=0):
    return tgt.clone().index_add_(axis, idx, src)
def _segment_sum(src, seg, n):
    out = torch.zeros((n,) + src.shape[1:], dtype=src.dtype)
    return out.index_add_(0, seg, src)
def _pad(x, pw):
    flat = tuple(v for pair in reversed(pw) for v in pair)
    return torch.nn.functional.pad(x, flat)

kernel_name = 'standalone__gqa_block_cached__near_ridge'

def setup_inputs():

    _w = (lambda a: (lambda t: t.to(torch.bfloat16) if t.is_floating_point() else t)(torch.as_tensor(a)))
    B, Sq, D = 16, 96, 640
    Hq, Hkv, Sk, Dh = 32, 32, 512, 128
    assert Hq % Hkv == 0, (Hq, Hkv)
    return {
        "x": _w((lambda *s: torch.randn(*s, dtype=torch.bfloat16) * 0.8)(B, Sq, D)),
        "k_cache": _w((lambda *s: torch.randn(*s, dtype=torch.bfloat16) * 0.8)(B, Hkv, Sk, Dh)),
        "v_cache": _w((lambda *s: torch.randn(*s, dtype=torch.bfloat16) * 0.05)(B, Hkv, Sk, Dh)),
        "wq": _w((lambda *s: torch.randn(*s, dtype=torch.bfloat16) * 0.8)(D, Hq * Dh) * (D ** -0.5)),
        "wo": _w((lambda *s: torch.randn(*s, dtype=torch.bfloat16) * 0.05)(Hq * Dh, D) * ((Hq * Dh) ** -0.5)),
    }

def reference(x, k_cache, v_cache, wq, wo):
    B, Sq, D = x.shape
    Hq, Dh = 32, 128
    Hkv = k_cache.shape[1]
    rep = Hq // Hkv
    q = (lambda x, *d: x.permute(*d))((x @ wq).reshape(B, Sq, Hq, Dh), 0, 2, 1, 3)
    k = (lambda x, n, axis: torch.repeat_interleave(x, n, dim=axis))(k_cache, rep, axis=1)
    v = (lambda x, n, axis: torch.repeat_interleave(x, n, dim=axis))(v_cache, rep, axis=1)
    scores = torch.einsum("bhqd,bhkd->bhqk", q, k) * (Dh ** -0.5)
    p = _softmax(scores, axis=-1)
    o = torch.einsum("bhqk,bhkd->bhqd", p, v)
    return (lambda x, *d: x.permute(*d))(o, 0, 2, 1, 3).reshape(B, Sq, Hq * Dh) @ wo
```

```asm
; @launch grid=(256,1,1) block=(256,1,1) lds=163840

.amdgcn_target "amdgcn-amd-amdhsa--gfx950"
.text
.globl standalone__gqa_block_cached__near_ridge_kernel
.p2align 8
.type standalone__gqa_block_cached__near_ridge_kernel,@function
standalone__gqa_block_cached__near_ridge_kernel:
    s_load_dwordx16 s[64:79], s[0:1], 0
    s_cmp_ge_u32 s2, 256
    s_cbranch_scc1 L_end
    s_getpc_b64 s[40:41]
L_pc0:
    s_bfe_u32 s46, s2, 0x30003
    s_lshl_b32 s46, s46, 13
    v_lshrrev_b32 v16, 2, v0
    v_lshlrev_b32 v16, 7, v16
    v_add_u32 v16, s46, v16
    v_min_u32 v16, L_codeend-L_pc0-4, v16
    v_mov_b32 v19, s41
    v_add_co_u32 v18, vcc, s40, v16
    s_nop 1
    v_addc_co_u32 v19, vcc, 0, v19, vcc
    global_load_dword v120, v[18:19], off
    v_lshrrev_b32 v9, 6, v0
    v_and_b32 v1, 63, v0
    s_and_b32 s46, s2, 3
    s_lshl_b32 s46, s46, 2
    v_readfirstlane_b32 s36, v9
    s_bfe_u32 s47, s2, 0x20003
    s_add_u32 s37, s46, s47
    s_bfe_u32 s46, s2, 0x10002
    s_lshl_b32 s46, s46, 3
    s_lshr_b32 s47, s2, 5
    s_add_u32 s38, s46, s47
    v_lshrrev_b32 v9, 3, v1
    v_and_b32 v10, 7, v1
    v_lshrrev_b32 v11, 4, v1
    v_and_b32 v16, 1, v11
    v_lshlrev_b32 v16, 2, v16
    v_xor_b32 v16, v16, v10
    v_lshlrev_b32 v16, 4, v16
    v_lshl_add_u32 v4, v9, 13, v16
    s_and_b32 s46, s36, 1
    s_lshl_b32 s46, s46, 2
    v_xor_b32 v16, v10, v11
    v_xor_b32 v16, s46, v16
    v_mul_u32_u24 v17, 1280, v9
    v_lshl_add_u32 v5, v16, 4, v17
    s_lshl_b32 s47, s37, 9
    s_lshl_b32 s46, s36, 7
    s_add_u32 s50, s47, s46
    s_mul_i32 s51, s38, 96
    s_lshl_b32 s46, s36, 3
    s_add_u32 s51, s51, s46
    s_mul_i32 s51, s51, 1280
    s_lshl_b32 s52, s36, 13
    s_lshl_b32 s53, s36, 10
    s_add_u32 s53, s53, 32768
    s_mov_b32 s45, 0
    s_waitcnt lgkmcnt(0)
    s_mov_b32 s16, s70
    s_and_b32 s17, s71, 0xffff
    s_mov_b32 s18, 5242880
    s_mov_b32 s19, 0x00020000
    s_mov_b32 s4, s64
    s_and_b32 s5, s65, 0xffff
    s_mov_b32 s6, 1966080
    s_mov_b32 s7, 0x00020000
    s_mov_b32 m0, s52
    s_nop 0
    buffer_load_dwordx4 v4, s[16:19], s50 offen lds
    s_add_u32 m0, m0, 1024
    s_add_u32 s50, s50, 65536
    buffer_load_dwordx4 v4, s[16:19], s50 offen lds
    s_add_u32 m0, m0, 1024
    s_add_u32 s50, s50, 65536
    buffer_load_dwordx4 v4, s[16:19], s50 offen lds
    s_add_u32 m0, m0, 1024
    s_add_u32 s50, s50, 65536
    buffer_load_dwordx4 v4, s[16:19], s50 offen lds
    s_add_u32 m0, m0, 1024
    s_add_u32 s50, s50, 65536
    buffer_load_dwordx4 v4, s[16:19], s50 offen lds
    s_add_u32 m0, m0, 1024
    s_add_u32 s50, s50, 65536
    buffer_load_dwordx4 v4, s[16:19], s50 offen lds
    s_add_u32 m0, m0, 1024
    s_add_u32 s50, s50, 65536
    buffer_load_dwordx4 v4, s[16:19], s50 offen lds
    s_add_u32 m0, m0, 1024
    s_add_u32 s50, s50, 65536
    buffer_load_dwordx4 v4, s[16:19], s50 offen lds
    s_mov_b32 m0, s53
    s_add_u32 s50, s50, 65536
    buffer_load_dwordx4 v5, s[4:7], s51 offen lds
    s_add_u32 m0, m0, 4096
    s_add_u32 s51, s51, 40960
    buffer_load_dwordx4 v5, s[4:7], s51 offen lds
    s_add_u32 m0, m0, 4096
    s_add_u32 s51, s51, 40960
    buffer_load_dwordx4 v5, s[4:7], s51 offen lds
    s_sub_u32 s51, s51, 81792
    s_add_u32 s52, s52, 45056
    s_add_u32 s53, s53, 45056
    s_mov_b32 s8, s66
    s_and_b32 s9, s67, 0xffff
    s_mov_b32 s10, 67108864
    s_mov_b32 s11, 0x00020000
    s_mov_b32 s12, s68
    s_and_b32 s13, s69, 0xffff
    s_mov_b32 s14, 67108864
    s_mov_b32 s15, 0x00020000
    s_mov_b32 s20, s78
    s_and_b32 s21, s79, 0xffff
    s_mov_b32 s22, 268435456
    s_mov_b32 s23, 0x00020000
    s_mov_b32 s24, s72
    s_and_b32 s25, s73, 0xffff
    s_mov_b32 s26, 5242880
    s_mov_b32 s27, 0x00020000
    s_mov_b32 s28, s74
    s_and_b32 s29, s75, 0xffff
    s_mov_b32 s30, 1966080
    s_mov_b32 s31, 0x00020000
    s_mov_b32 s32, s76
    s_and_b32 s33, s77, 0xffff
    s_mov_b32 s34, 256
    s_mov_b32 s35, 0x00020000
    v_lshlrev_b32 v2, 4, v1
    v_add_u32 v3, 4096, v2
    v_and_b32 v16, 15, v1
    v_lshlrev_b32 v17, 2, v11
    v_xor_b32 v16, v16, v17
    v_lshlrev_b32 v17, 8, v11
    v_lshl_add_u32 v6, v16, 4, v17
    v_and_b32 v16, 31, v1
    v_lshrrev_b32 v17, 5, v1
    v_bfe_u32 v18, v1, 2, 2
    v_bfe_u32 v19, v1, 4, 1
    v_and_b32 v20, 3, v1
    v_and_b32 v21, 1, v20
    v_lshlrev_b32 v21, 1, v21
    v_lshrrev_b32 v22, 1, v20
    v_or_b32 v21, v21, v22
    v_lshlrev_b32 v22, 10, v17
    v_lshl_add_u32 v22, v18, 7, v22
    v_lshl_add_u32 v22, v19, 5, v22
    v_lshl_add_u32 v22, v21, 3, v22
    v_lshrrev_b32 v23, 1, v18
    v_lshl_add_u32 v22, v23, 6, v22
    s_lshl_b32 s46, s36, 13
    v_add_u32 v7, s46, v22
    v_xor_b32 v8, 64, v7
    v_bfe_u32 v21, v16, 1, 3
    v_xor_b32 v21, v21, v17
    v_lshlrev_b32 v22, 7, v16
    v_add_u32 v22, 32768, v22
    v_xor_b32 v23, 0, v21
    v_lshl_add_u32 v192, v23, 4, v22
    v_xor_b32 v23, 2, v21
    v_lshl_add_u32 v193, v23, 4, v22
    v_xor_b32 v23, 4, v21
    v_lshl_add_u32 v194, v23, 4, v22
    v_xor_b32 v23, 6, v21
    v_lshl_add_u32 v195, v23, 4, v22
    v_lshrrev_b32 v21, 2, v16
    v_mul_u32_u24 v21, 1040, v21
    v_and_b32 v22, 3, v16
    v_lshl_add_u32 v21, v22, 8, v21
    v_lshl_add_u32 v21, v17, 4, v21
    v_xor_b32 v23, 0, v22
    v_lshl_add_u32 v176, v23, 6, v21
    v_xor_b32 v23, 1, v22
    v_lshl_add_u32 v177, v23, 6, v21
    v_xor_b32 v23, 2, v22
    v_lshl_add_u32 v178, v23, 6, v21
    v_xor_b32 v23, 3, v22
    v_lshl_add_u32 v179, v23, 6, v21
    v_mul_u32_u24 v21, 1040, v17
    v_lshl_add_u32 v21, v18, 8, v21
    v_lshl_add_u32 v21, v19, 5, v21
    v_lshl_add_u32 v21, v20, 3, v21
    v_add_u32 v21, 74880, v21
    v_xor_b32 v23, 0, v18
    v_lshl_add_u32 v184, v23, 6, v21
    v_xor_b32 v23, 1, v18
    v_lshl_add_u32 v185, v23, 6, v21
    v_xor_b32 v23, 2, v18
    v_lshl_add_u32 v186, v23, 6, v21
    v_xor_b32 v23, 3, v18
    v_lshl_add_u32 v187, v23, 6, v21
    s_lshl_b32 s46, s36, 12
    s_add_u32 s46, s46, 114688
    v_add_u32 v205, s46, v2
    s_mov_b32 s42, 0x3e0293ee
    s_mov_b32 s43, s42
    s_mov_b32 s44, 0x41200000
    s_mov_b32 s39, 0
    s_mov_b32 s82, 0
    v_mov_b32 v211, 160256
    v_mov_b32 v12, 0
    v_mov_b32 v13, 0
    v_mov_b32 v14, 0
    v_mov_b32 v15, 0
    s_nop 1
    v_mfma_f32_32x32x16_bf16 v[16:31], v[12:15], v[12:15], 0
    v_mfma_f32_32x32x16_bf16 v[32:47], v[12:15], v[12:15], 0
    v_mfma_f32_32x32x16_bf16 v[48:63], v[12:15], v[12:15], 0
    v_mfma_f32_32x32x16_bf16 v[64:79], v[12:15], v[12:15], 0
    v_mfma_f32_32x32x16_bf16 v[80:95], v[12:15], v[12:15], 0
    v_mfma_f32_32x32x16_bf16 v[96:111], v[12:15], v[12:15], 0
    v_mfma_f32_32x32x16_bf16 a[16:31], v[12:15], v[12:15], 0
    v_mfma_f32_32x32x16_bf16 a[32:47], v[12:15], v[12:15], 0
    s_mov_b32 m0, s52
    s_nop 0
    buffer_load_dwordx4 v4, s[16:19], s50 offen lds
    s_add_u32 m0, m0, 1024
    s_add_u32 s50, s50, 65536
    buffer_load_dwordx4 v4, s[16:19], s50 offen lds
    s_add_u32 m0, m0, 1024
    s_add_u32 s50, s50, 65536
    buffer_load_dwordx4 v4, s[16:19], s50 offen lds
    s_add_u32 m0, m0, 1024
    s_add_u32 s50, s50, 65536
    buffer_load_dwordx4 v4, s[16:19], s50 offen lds
    s_add_u32 m0, m0, 1024
    s_add_u32 s50, s50, 65536
    buffer_load_dwordx4 v4, s[16:19], s50 offen lds
    s_add_u32 m0, m0, 1024
    s_add_u32 s50, s50, 65536
    buffer_load_dwordx4 v4, s[16:19], s50 offen lds
    s_add_u32 m0, m0, 1024
    s_add_u32 s50, s50, 65536
    buffer_load_dwordx4 v4, s[16:19], s50 offen lds
    s_add_u32 m0, m0, 1024
    s_add_u32 s50, s50, 65536
    buffer_load_dwordx4 v4, s[16:19], s50 offen lds
    s_mov_b32 m0, s53
    s_add_u32 s50, s50, 65536
    buffer_load_dwordx4 v5, s[4:7], s51 offen lds
    s_add_u32 m0, m0, 4096
    s_add_u32 s51, s51, 40960
    buffer_load_dwordx4 v5, s[4:7], s51 offen lds
    s_add_u32 m0, m0, 4096
    s_add_u32 s51, s51, 40960
    buffer_load_dwordx4 v5, s[4:7], s51 offen lds
    s_sub_u32 s51, s51, 81792
    s_add_u32 s52, s52, 45056
    s_add_u32 s53, s53, 45056
    s_lshr_b32 s46, s2, 3
    s_cmp_lt_u32 s46, 30
    s_cselect_b32 s3, 0, 2130706432
    s_mul_i32 s47, s46, 52
    s_lshr_b32 s47, s47, 8
    s_mul_i32 s48, s47, 5
    s_sub_u32 s48, s46, s48
    s_add_u32 s64, s48, s47
    s_and_b32 s64, s64, 3
    s_bfe_u32 s49, s2, 0x10002
    s_mul_i32 s49, s49, 6
    s_add_u32 s49, s49, s47
    s_lshl_b32 s49, s49, 2
    s_and_b32 s56, s2, 3
    s_mul_i32 s46, s49, 86
    s_lshr_b32 s46, s46, 8
    s_and_b32 s46, s46, 7
    s_lshl_b32 s46, s46, 5
    s_and_b32 s47, s2, 7
    s_or_b32 s46, s46, s47
    s_lshl_b32 s46, s46, 9
    s_add_u32 s80, s46, 25198976
    s_add_u32 s49, s49, s36
    s_mul_i32 s46, s49, 86
    s_lshr_b32 s46, s46, 8
    s_mul_i32 s70, s46, 3
    s_sub_u32 s70, s49, s70
    s_lshl_b32 s70, s70, 7
    s_and_b32 s46, s46, 7
    s_lshl_b32 s46, s46, 5
    s_or_b32 s46, s46, s47
    s_lshl_b32 s46, s46, 9
    s_add_u32 s70, s70, s46
    s_add_u32 s70, s70, 25198592
    v_and_b32 v9, 3, v1
    v_lshlrev_b32 v206, 12, v9
    s_lshl_b32 s61, s49, 18
    s_lshl_b32 s46, s56, 15
    s_add_u32 s61, s61, s46
    s_add_u32 s61, s61, s3
    s_mul_i32 s79, s56, 1310720
    s_lshl_b32 s46, s48, 8
    s_add_u32 s79, s79, s46
    s_add_u32 s79, s79, s3
    s_mul_i32 s47, s36, 10240
    s_add_u32 s62, s79, s47
    s_mul_i32 s81, s36, 2080
    s_mul_i32 s69, s49, 40960
    s_add_u32 s69, s69, s46
    s_lshl_b32 s46, s56, 6
    s_add_u32 s69, s69, s46
    s_mul_i32 s47, s36, 6144
    s_add_u32 s47, s47, 26214400
    s_mul_i32 s65, s2, 24576
    s_add_u32 s65, s65, s47
    v_bfe_u32 v10, v1, 2, 2
    v_lshlrev_b32 v9, 6, v10
    v_sub_u32 v9, v184, v9
    v_subrev_u32 v9, 74880, v9
    s_add_u32 s46, s56, 1
    s_and_b32 s46, s46, 3
    v_xor_b32 v212, s46, v10
    v_lshl_add_u32 v212, v212, 6, v9
    s_and_b32 s48, s2, -4
    s_or_b32 s46, s46, s48
    s_mul_i32 s46, s46, 24576
    s_add_u32 s46, s46, s47
    s_add_u32 s66, s46, 0
    s_add_u32 s46, s56, 2
    s_and_b32 s46, s46, 3
    v_xor_b32 v213, s46, v10
    v_lshl_add_u32 v213, v213, 6, v9
    s_and_b32 s48, s2, -4
    s_or_b32 s46, s46, s48
    s_mul_i32 s46, s46, 24576
    s_add_u32 s46, s46, s47
    s_add_u32 s67, s46, 2048
    s_add_u32 s46, s56, 3
    s_and_b32 s46, s46, 3
    v_xor_b32 v214, s46, v10
    v_lshl_add_u32 v214, v214, 6, v9
    s_and_b32 s48, s2, -4
    s_or_b32 s46, s46, s48
    s_mul_i32 s46, s46, 24576
    s_add_u32 s46, s46, s47
    s_add_u32 s68, s46, 4096
    s_add_u32 s46, s56, 4
    s_and_b32 s46, s46, 3
    v_xor_b32 v215, s46, v10
    v_lshl_add_u32 v215, v215, 6, v9
    v_add_u32 v216, 58240, v212
    v_add_u32 v217, 58240, v213
    v_add_u32 v218, 58240, v214
    v_add_u32 v219, 58240, v215
    v_add_u32 v220, 116480, v212
    v_add_u32 v221, 116480, v213
    v_add_u32 v222, 116480, v214
    v_add_u32 v223, 116480, v215
    v_lshrrev_b32 v9, 4, v1
    v_mul_u32_u24 v9, 1024, v9
    v_add_u32 v207, v9, v6
    v_and_b32 v9, 31, v1
    v_mul_u32_u24 v9, 1280, v9
    v_lshrrev_b32 v10, 5, v1
    v_lshl_add_u32 v204, v10, 4, v9
    v_add_u32 v248, 0, v207
    v_add_u32 v249, 5120, v207
    v_add_u32 v250, 40960, v207
    v_add_u32 v251, 46080, v207
    v_add_u32 v252, 81920, v207
    v_add_u32 v253, 87040, v207
    v_add_u32 v254, 122880, v207
    v_add_u32 v255, 128000, v207
    s_add_u32 s46, s64, 0
    s_and_b32 s46, s46, 3
    s_lshl_b32 s56, s46, 13
    s_add_u32 s46, s64, 1
    s_and_b32 s46, s46, 3
    s_lshl_b32 s0, s46, 13
    s_add_u32 s46, s64, 2
    s_and_b32 s46, s46, 3
    s_lshl_b32 s71, s46, 13
    s_add_u32 s46, s64, 3
    s_and_b32 s46, s46, 3
    s_lshl_b32 s83, s46, 13
    s_lshl_b32 s64, s64, 2
    s_lshl_b32 s46, s2, 9
    s_lshl_b32 s47, s36, 7
    s_add_u32 s46, s46, s47
    s_add_u32 s46, s46, 32768
    s_cmp_eq_u32 s36, 3
    s_cselect_b32 s46, 2130706432, s46
    v_cmp_eq_u32 vcc, 0, v1
    v_mov_b32 v9, 2130706432
    v_mov_b32 v10, s46
    v_cndmask_b32 v210, v9, v10, vcc
    s_mov_b32 s63, 0
    s_cmp_eq_u32 s36, 3
    s_cbranch_scc1 L_w3
    s_cmp_eq_u32 s36, 1
    s_cselect_b32 s72, s12, s8
    s_cselect_b32 s73, s13, s9
    s_mov_b32 s74, 67108864
    s_mov_b32 s75, 0x00020000
    s_mov_b32 s77, 58240
    s_cselect_b32 s77, 124800, s77
    s_mov_b32 s79, 74880
    s_cselect_b32 s79, 149760, s79
    s_lshr_b32 s46, s36, 1
    s_mul_i32 s47, s46, 8320
    s_add_u32 s77, s77, s47
    s_lshl_b32 s46, s38, 4
    s_add_u32 s46, s46, s37
    s_lshl_b32 s76, s46, 18
    s_mov_b32 s58, s79
    s_mov_b32 s79, 0
    s_mov_b32 s78, 0
    s_mov_b32 s60, 0
L_cv0:
    s_cmp_eq_u32 s36, 1
    s_cbranch_scc1 L_qd01
    s_cmp_eq_u32 s36, 2
    s_cbranch_scc1 L_qd02
L_qd00:
    s_waitcnt vmcnt(11)
    s_mov_b64 vcc, -1
    s_call_b64 s[40:41], L_qbody
    s_add_u32 s47, s63, 73728
    s_and_b32 s47, s47, 0x1ffff
    s_add_u32 s47, s47, s76
    s_add_u32 s46, s47, 4096
    buffer_load_dwordx4 a[96:99], v6, s[72:75], s47 offen offset:0 nt
    buffer_load_dwordx4 a[100:103], v6, s[72:75], s47 offen offset:1024 nt
    buffer_load_dwordx4 a[104:107], v6, s[72:75], s47 offen offset:2048 nt
    buffer_load_dwordx4 a[108:111], v6, s[72:75], s47 offen offset:3072 nt
    buffer_load_dwordx4 a[112:115], v6, s[72:75], s46 offen offset:0 nt
    buffer_load_dwordx4 a[116:119], v6, s[72:75], s46 offen offset:1024 nt
    buffer_load_dwordx4 a[120:123], v6, s[72:75], s46 offen offset:2048 nt
    buffer_load_dwordx4 a[124:127], v6, s[72:75], s46 offen offset:3072 nt
    s_waitcnt vmcnt(19)
    s_call_b64 s[40:41], L_qbody
    s_waitcnt vmcnt(19)
    s_call_b64 s[40:41], L_qbody
    s_waitcnt vmcnt(11)
    s_call_b64 s[40:41], L_qbody
    s_add_u32 s47, s63, 98304
    s_and_b32 s47, s47, 0x1ffff
    s_add_u32 s47, s47, s76
    s_add_u32 s46, s47, 4096
    buffer_load_dwordx4 a[128:131], v6, s[72:75], s47 offen offset:0 nt
    buffer_load_dwordx4 a[132:135], v6, s[72:75], s47 offen offset:1024 nt
    buffer_load_dwordx4 a[136:139], v6, s[72:75], s47 offen offset:2048 nt
    buffer_load_dwordx4 a[140:143], v6, s[72:75], s47 offen offset:3072 nt
    buffer_load_dwordx4 a[144:147], v6, s[72:75], s46 offen offset:0 nt
    buffer_load_dwordx4 a[148:151], v6, s[72:75], s46 offen offset:1024 nt
    buffer_load_dwordx4 a[152:155], v6, s[72:75], s46 offen offset:2048 nt
    buffer_load_dwordx4 a[156:159], v6, s[72:75], s46 offen offset:3072 nt
    s_waitcnt vmcnt(19)
    s_call_b64 s[40:41], L_qbody
    s_waitcnt vmcnt(19)
    s_call_b64 s[40:41], L_qbody
    s_waitcnt vmcnt(11)
    s_call_b64 s[40:41], L_qbody
    s_add_u32 s47, s63, 122880
    s_and_b32 s47, s47, 0x1ffff
    s_add_u32 s47, s47, s76
    s_add_u32 s46, s47, 4096
    buffer_load_dwordx4 a[160:163], v6, s[72:75], s47 offen offset:0 nt
    buffer_load_dwordx4 a[164:167], v6, s[72:75], s47 offen offset:1024 nt
    buffer_load_dwordx4 a[168:171], v6, s[72:75], s47 offen offset:2048 nt
    buffer_load_dwordx4 a[172:175], v6, s[72:75], s47 offen offset:3072 nt
    buffer_load_dwordx4 a[176:179], v6, s[72:75], s46 offen offset:0 nt
    buffer_load_dwordx4 a[180:183], v6, s[72:75], s46 offen offset:1024 nt
    buffer_load_dwordx4 a[184:187], v6, s[72:75], s46 offen offset:2048 nt
    buffer_load_dwordx4 a[188:191], v6, s[72:75], s46 offen offset:3072 nt
    s_waitcnt vmcnt(19)
    s_call_b64 s[40:41], L_qbody
    s_waitcnt vmcnt(19)
    s_mov_b64 vcc, 0
    s_mov_b32 s55, 0
    s_call_b64 s[40:41], L_qbody
    s_waitcnt vmcnt(0)
    s_mov_b32 s55, 0
    s_call_b64 s[40:41], L_qbody
    s_add_u32 s54, s76, 65536
    s_mov_b32 s55, 49920
    s_branch L_qend
L_qd01:
    s_waitcnt vmcnt(11)
    s_mov_b64 vcc, -1
    s_call_b64 s[40:41], L_qbody
    s_waitcnt vmcnt(11)
    s_call_b64 s[40:41], L_qbody
    s_add_u32 s47, s63, 65536
    s_and_b32 s47, s47, 0x1ffff
    s_add_u32 s47, s47, s76
    s_add_u32 s46, s47, 4096
    buffer_load_dwordx4 a[96:99], v6, s[72:75], s47 offen offset:0 nt
    buffer_load_dwordx4 a[100:103], v6, s[72:75], s47 offen offset:1024 nt
    buffer_load_dwordx4 a[104:107], v6, s[72:75], s47 offen offset:2048 nt
    buffer_load_dwordx4 a[108:111], v6, s[72:75], s47 offen offset:3072 nt
    buffer_load_dwordx4 a[112:115], v6, s[72:75], s46 offen offset:0 nt
    buffer_load_dwordx4 a[116:119], v6, s[72:75], s46 offen offset:1024 nt
    buffer_load_dwordx4 a[120:123], v6, s[72:75], s46 offen offset:2048 nt
    buffer_load_dwordx4 a[124:127], v6, s[72:75], s46 offen offset:3072 nt
    s_waitcnt vmcnt(19)
    s_call_b64 s[40:41], L_qbody
    s_waitcnt vmcnt(19)
    s_call_b64 s[40:41], L_qbody
    s_waitcnt vmcnt(11)
    s_call_b64 s[40:41], L_qbody
    s_add_u32 s47, s63, 90112
    s_and_b32 s47, s47, 0x1ffff
    s_add_u32 s47, s47, s76
    s_add_u32 s46, s47, 4096
    buffer_load_dwordx4 a[128:131], v6, s[72:75], s47 offen offset:0 nt
    buffer_load_dwordx4 a[132:135], v6, s[72:75], s47 offen offset:1024 nt
    buffer_load_dwordx4 a[136:139], v6, s[72:75], s47 offen offset:2048 nt
    buffer_load_dwordx4 a[140:143], v6, s[72:75], s47 offen offset:3072 nt
    buffer_load_dwordx4 a[144:147], v6, s[72:75], s46 offen offset:0 nt
    buffer_load_dwordx4 a[148:151], v6, s[72:75], s46 offen offset:1024 nt
    buffer_load_dwordx4 a[152:155], v6, s[72:75], s46 offen offset:2048 nt
    buffer_load_dwordx4 a[156:159], v6, s[72:75], s46 offen offset:3072 nt
    s_waitcnt vmcnt(19)
    s_call_b64 s[40:41], L_qbody
    s_waitcnt vmcnt(19)
    s_call_b64 s[40:41], L_qbody
    s_waitcnt vmcnt(11)
    s_call_b64 s[40:41], L_qbody
    s_add_u32 s47, s63, 114688
    s_and_b32 s47, s47, 0x1ffff
    s_add_u32 s47, s47, s76
    s_add_u32 s46, s47, 4096
    buffer_load_dwordx4 a[160:163], v6, s[72:75], s47 offen offset:0 nt
    buffer_load_dwordx4 a[164:167], v6, s[72:75], s47 offen offset:1024 nt
    buffer_load_dwordx4 a[168:171], v6, s[72:75], s47 offen offset:2048 nt
    buffer_load_dwordx4 a[172:175], v6, s[72:75], s47 offen offset:3072 nt
    buffer_load_dwordx4 a[176:179], v6, s[72:75], s46 offen offset:0 nt
    buffer_load_dwordx4 a[180:183], v6, s[72:75], s46 offen offset:1024 nt
    buffer_load_dwordx4 a[184:187], v6, s[72:75], s46 offen offset:2048 nt
    buffer_load_dwordx4 a[188:191], v6, s[72:75], s46 offen offset:3072 nt
    s_waitcnt vmcnt(19)
    s_mov_b64 vcc, 0
    s_mov_b32 s55, 0
    s_call_b64 s[40:41], L_qbody
    s_waitcnt vmcnt(8)
    s_mov_b32 s55, 0
    s_call_b64 s[40:41], L_qbody
    s_add_u32 s54, s76, 16384
    s_mov_b32 s55, 74880
    s_branch L_qend
L_qd02:
    s_waitcnt vmcnt(11)
    s_mov_b64 vcc, -1
    s_call_b64 s[40:41], L_qbody
    s_waitcnt vmcnt(11)
    s_call_b64 s[40:41], L_qbody
    s_waitcnt vmcnt(11)
    s_call_b64 s[40:41], L_qbody
    s_add_u32 s47, s63, 81920
    s_and_b32 s47, s47, 0x1ffff
    s_add_u32 s47, s47, s76
    s_add_u32 s46, s47, 4096
    buffer_load_dwordx4 a[96:99], v6, s[72:75], s47 offen offset:0 nt
    buffer_load_dwordx4 a[100:103], v6, s[72:75], s47 offen offset:1024 nt
    buffer_load_dwordx4 a[104:107], v6, s[72:75], s47 offen offset:2048 nt
    buffer_load_dwordx4 a[108:111], v6, s[72:75], s47 offen offset:3072 nt
    buffer_load_dwordx4 a[112:115], v6, s[72:75], s46 offen offset:0 nt
    buffer_load_dwordx4 a[116:119], v6, s[72:75], s46 offen offset:1024 nt
    buffer_load_dwordx4 a[120:123], v6, s[72:75], s46 offen offset:2048 nt
    buffer_load_dwordx4 a[124:127], v6, s[72:75], s46 offen offset:3072 nt
    s_waitcnt vmcnt(19)
    s_call_b64 s[40:41], L_qbody
    s_waitcnt vmcnt(19)
    s_call_b64 s[40:41], L_qbody
    s_waitcnt vmcnt(11)
    s_call_b64 s[40:41], L_qbody
    s_add_u32 s47, s63, 106496
    s_and_b32 s47, s47, 0x1ffff
    s_add_u32 s47, s47, s76
    s_add_u32 s46, s47, 4096
    buffer_load_dwordx4 a[128:131], v6, s[72:75], s47 offen offset:0 nt
    buffer_load_dwordx4 a[132:135], v6, s[72:75], s47 offen offset:1024 nt
    buffer_load_dwordx4 a[136:139], v6, s[72:75], s47 offen offset:2048 nt
    buffer_load_dwordx4 a[140:143], v6, s[72:75], s47 offen offset:3072 nt
    buffer_load_dwordx4 a[144:147], v6, s[72:75], s46 offen offset:0 nt
    buffer_load_dwordx4 a[148:151], v6, s[72:75], s46 offen offset:1024 nt
    buffer_load_dwordx4 a[152:155], v6, s[72:75], s46 offen offset:2048 nt
    buffer_load_dwordx4 a[156:159], v6, s[72:75], s46 offen offset:3072 nt
    s_waitcnt vmcnt(19)
    s_call_b64 s[40:41], L_qbody
    s_waitcnt vmcnt(19)
    s_call_b64 s[40:41], L_qbody
    s_waitcnt vmcnt(11)
    s_mov_b64 vcc, 0
    s_mov_b32 s55, 0
    s_call_b64 s[40:41], L_qbody
    s_add_u32 s47, s63, 0
    s_and_b32 s47, s47, 0x1ffff
    s_add_u32 s47, s47, s76
    s_add_u32 s47, s47, 0x20000
    s_add_u32 s46, s47, 4096
    buffer_load_dwordx4 a[160:163], v6, s[72:75], s47 offen offset:0 nt
    buffer_load_dwordx4 a[164:167], v6, s[72:75], s47 offen offset:1024 nt
    buffer_load_dwordx4 a[168:171], v6, s[72:75], s47 offen offset:2048 nt
    buffer_load_dwordx4 a[172:175], v6, s[72:75], s47 offen offset:3072 nt
    buffer_load_dwordx4 a[176:179], v6, s[72:75], s46 offen offset:0 nt
    buffer_load_dwordx4 a[180:183], v6, s[72:75], s46 offen offset:1024 nt
    buffer_load_dwordx4 a[184:187], v6, s[72:75], s46 offen offset:2048 nt
    buffer_load_dwordx4 a[188:191], v6, s[72:75], s46 offen offset:3072 nt
    s_waitcnt vmcnt(8)
    s_mov_b32 s55, 0
    s_call_b64 s[40:41], L_qbody
    s_mov_b32 s72, s12
    s_mov_b32 s73, s13
    s_add_u32 s54, s76, 24576
    s_mov_b32 s55, 83200
L_qend:
    s_waitcnt lgkmcnt(0)
    v_mfma_f32_32x32x16_bf16 v[16:31], a[20:23], a[28:31], v[16:31]
    s_add_u32 m0, s55, 0
    s_nop 0
    buffer_load_dwordx4 v6, s[72:75], s54 offen offset:0 nt lds
    v_mfma_f32_32x32x16_bf16 v[32:47], a[20:23], a[32:35], v[32:47]
    s_add_u32 m0, s55, 16
    s_nop 0
    buffer_load_dwordx4 v6, s[72:75], s54 offen offset:1024 nt lds
    v_mfma_f32_32x32x16_bf16 v[48:63], a[20:23], a[36:39], v[48:63]
    s_add_u32 m0, s55, 32
    s_nop 0
    buffer_load_dwordx4 v6, s[72:75], s54 offen offset:2048 nt lds
    v_mfma_f32_32x32x16_bf16 v[64:79], a[24:27], a[28:31], v[64:79]
    s_add_u32 m0, s55, 48
    s_nop 0
    buffer_load_dwordx4 v6, s[72:75], s54 offen offset:3072 nt lds
    v_mfma_f32_32x32x16_bf16 v[80:95], a[24:27], a[32:35], v[80:95]
    s_add_u32 m0, s55, 4160
    s_add_u32 s54, s54, 4096
    buffer_load_dwordx4 v6, s[72:75], s54 offen offset:0 nt lds
    v_mfma_f32_32x32x16_bf16 v[96:111], a[24:27], a[36:39], v[96:111]
    s_add_u32 m0, s55, 4176
    s_nop 0
    buffer_load_dwordx4 v6, s[72:75], s54 offen offset:1024 nt lds
    s_nop 6
    v_pk_mul_f32 v[16:17], v[16:17], s[42:43]
    v_pk_mul_f32 v[18:19], v[18:19], s[42:43]
    v_pk_mul_f32 v[20:21], v[20:21], s[42:43]
    v_pk_mul_f32 v[22:23], v[22:23], s[42:43]
    v_pk_mul_f32 v[24:25], v[24:25], s[42:43]
    v_pk_mul_f32 v[26:27], v[26:27], s[42:43]
    v_pk_mul_f32 v[28:29], v[28:29], s[42:43]
    v_pk_mul_f32 v[30:31], v[30:31], s[42:43]
    v_cvt_pk_bf16_f32 v16, v16, v17
    v_cvt_pk_bf16_f32 v17, v18, v19
    v_cvt_pk_bf16_f32 v18, v20, v21
    v_cvt_pk_bf16_f32 v19, v22, v23
    v_cvt_pk_bf16_f32 v20, v24, v25
    v_cvt_pk_bf16_f32 v21, v26, v27
    v_cvt_pk_bf16_f32 v22, v28, v29
    v_cvt_pk_bf16_f32 v23, v30, v31
    ds_write_b128 v205, v[16:19] offset:0
    ds_write_b128 v205, v[20:23] offset:1024
    s_add_u32 m0, s55, 4192
    s_nop 0
    buffer_load_dwordx4 v6, s[72:75], s54 offen offset:2048 nt lds
    s_add_u32 m0, s55, 4208
    s_nop 0
    buffer_load_dwordx4 v6, s[72:75], s54 offen offset:3072 nt lds
    v_pk_mul_f32 v[32:33], v[32:33], s[42:43]
    v_pk_mul_f32 v[34:35], v[34:35], s[42:43]
    v_pk_mul_f32 v[36:37], v[36:37], s[42:43]
    v_pk_mul_f32 v[38:39], v[38:39], s[42:43]
    v_pk_mul_f32 v[40:41], v[40:41], s[42:43]
    v_pk_mul_f32 v[42:43], v[42:43], s[42:43]
    v_pk_mul_f32 v[44:45], v[44:45], s[42:43]
    v_pk_mul_f32 v[46:47], v[46:47], s[42:43]
    v_cvt_pk_bf16_f32 v32, v32, v33
    v_cvt_pk_bf16_f32 v33, v34, v35
    v_cvt_pk_bf16_f32 v34, v36, v37
    v_cvt_pk_bf16_f32 v35, v38, v39
    v_cvt_pk_bf16_f32 v36, v40, v41
    v_cvt_pk_bf16_f32 v37, v42, v43
    v_cvt_pk_bf16_f32 v38, v44, v45
    v_cvt_pk_bf16_f32 v39, v46, v47
    ds_write_b128 v205, v[32:35] offset:16384
    ds_write_b128 v205, v[36:39] offset:17408
    v_pk_mul_f32 v[48:49], v[48:49], s[42:43]
    v_pk_mul_f32 v[50:51], v[50:51], s[42:43]
    v_pk_mul_f32 v[52:53], v[52:53], s[42:43]
    v_pk_mul_f32 v[54:55], v[54:55], s[42:43]
    v_pk_mul_f32 v[56:57], v[56:57], s[42:43]
    v_pk_mul_f32 v[58:59], v[58:59], s[42:43]
    v_pk_mul_f32 v[60:61], v[60:61], s[42:43]
    v_pk_mul_f32 v[62:63], v[62:63], s[42:43]
    v_cvt_pk_bf16_f32 v48, v48, v49
    v_cvt_pk_bf16_f32 v49, v50, v51
    v_cvt_pk_bf16_f32 v50, v52, v53
    v_cvt_pk_bf16_f32 v51, v54, v55
    v_cvt_pk_bf16_f32 v52, v56, v57
    v_cvt_pk_bf16_f32 v53, v58, v59
    v_cvt_pk_bf16_f32 v54, v60, v61
    v_cvt_pk_bf16_f32 v55, v62, v63
    ds_write_b128 v205, v[48:51] offset:32768
    ds_write_b128 v205, v[52:55] offset:33792
    v_pk_mul_f32 v[64:65], v[64:65], s[42:43]
    v_pk_mul_f32 v[66:67], v[66:67], s[42:43]
    v_pk_mul_f32 v[68:69], v[68:69], s[42:43]
    v_pk_mul_f32 v[70:71], v[70:71], s[42:43]
    v_pk_mul_f32 v[72:73], v[72:73], s[42:43]
    v_pk_mul_f32 v[74:75], v[74:75], s[42:43]
    v_pk_mul_f32 v[76:77], v[76:77], s[42:43]
    v_pk_mul_f32 v[78:79], v[78:79], s[42:43]
    v_cvt_pk_bf16_f32 v64, v64, v65
    v_cvt_pk_bf16_f32 v65, v66, v67
    v_cvt_pk_bf16_f32 v66, v68, v69
    v_cvt_pk_bf16_f32 v67, v70, v71
    v_cvt_pk_bf16_f32 v68, v72, v73
    v_cvt_pk_bf16_f32 v69, v74, v75
    v_cvt_pk_bf16_f32 v70, v76, v77
    v_cvt_pk_bf16_f32 v71, v78, v79
    ds_write_b128 v205, v[64:67] offset:2048
    ds_write_b128 v205, v[68:71] offset:3072
    v_pk_mul_f32 v[80:81], v[80:81], s[42:43]
    v_pk_mul_f32 v[82:83], v[82:83], s[42:43]
    v_pk_mul_f32 v[84:85], v[84:85], s[42:43]
    v_pk_mul_f32 v[86:87], v[86:87], s[42:43]
    v_pk_mul_f32 v[88:89], v[88:89], s[42:43]
    v_pk_mul_f32 v[90:91], v[90:91], s[42:43]
    v_pk_mul_f32 v[92:93], v[92:93], s[42:43]
    v_pk_mul_f32 v[94:95], v[94:95], s[42:43]
    v_cvt_pk_bf16_f32 v80, v80, v81
    v_cvt_pk_bf16_f32 v81, v82, v83
    v_cvt_pk_bf16_f32 v82, v84, v85
    v_cvt_pk_bf16_f32 v83, v86, v87
    v_cvt_pk_bf16_f32 v84, v88, v89
    v_cvt_pk_bf16_f32 v85, v90, v91
    v_cvt_pk_bf16_f32 v86, v92, v93
    v_cvt_pk_bf16_f32 v87, v94, v95
    ds_write_b128 v205, v[80:83] offset:18432
    ds_write_b128 v205, v[84:87] offset:19456
    v_pk_mul_f32 v[96:97], v[96:97], s[42:43]
    v_pk_mul_f32 v[98:99], v[98:99], s[42:43]
    v_pk_mul_f32 v[100:101], v[100:101], s[42:43]
    v_pk_mul_f32 v[102:103], v[102:103], s[42:43]
    v_pk_mul_f32 v[104:105], v[104:105], s[42:43]
    v_pk_mul_f32 v[106:107], v[106:107], s[42:43]
    v_pk_mul_f32 v[108:109], v[108:109], s[42:43]
    v_pk_mul_f32 v[110:111], v[110:111], s[42:43]
    v_cvt_pk_bf16_f32 v96, v96, v97
    v_cvt_pk_bf16_f32 v97, v98, v99
    v_cvt_pk_bf16_f32 v98, v100, v101
    v_cvt_pk_bf16_f32 v99, v102, v103
    v_cvt_pk_bf16_f32 v100, v104, v105
    v_cvt_pk_bf16_f32 v101, v106, v107
    v_cvt_pk_bf16_f32 v102, v108, v109
    v_cvt_pk_bf16_f32 v103, v110, v111
    ds_write_b128 v205, v[96:99] offset:34816
    ds_write_b128 v205, v[100:103] offset:35840
    s_waitcnt lgkmcnt(0)
    s_barrier
    s_cmp_eq_u32 s36, 3
    s_cbranch_scc1 L_w3a
    s_mul_i32 s46, s36, 12288
    v_add_u32 v205, s46, v205
    ds_read_b128 v[144:147], v205 offset:0
    ds_read_b128 v[148:151], v205 offset:1024
    ds_read_b128 v[152:155], v205 offset:2048
    ds_read_b128 v[156:159], v205 offset:3072
    ds_read_b128 v[160:163], v205 offset:4096
    ds_read_b128 v[164:167], v205 offset:5120
    ds_read_b128 v[168:171], v205 offset:6144
    ds_read_b128 v[172:175], v205 offset:7168
    s_mov_b32 s54, 58240
    s_mov_b32 s55, 41600
    v_add_u32 v180, s54, v176
    v_add_u32 v181, s54, v177
    v_add_u32 v182, s54, v178
    v_add_u32 v183, s54, v179
    ds_read_b128 a[0:3], v180 offset:0
    ds_read_b128 a[4:7], v180 offset:32
    ds_read_b128 a[8:11], v181 offset:0
    ds_read_b128 a[12:15], v181 offset:32
    ds_read_b128 a[16:19], v182 offset:0
    ds_read_b128 a[20:23], v182 offset:32
    ds_read_b128 a[24:27], v183 offset:0
    ds_read_b128 a[28:31], v183 offset:32
    s_add_u32 s54, s54, 8320
    s_cmp_eq_u32 s54, 74880
    s_cselect_b32 s54, 0, s54
    ds_read_b128 a[64:67], v205 offset:8192
    ds_read_b128 a[68:71], v205 offset:9216
    ds_read_b128 a[72:75], v205 offset:10240
    ds_read_b128 a[76:79], v205 offset:11264
    ds_read_b128 a[80:83], v205 offset:12288
    ds_read_b128 a[84:87], v205 offset:13312
    ds_read_b128 a[88:91], v205 offset:14336
    ds_read_b128 a[92:95], v205 offset:15360
    s_waitcnt lgkmcnt(8)
    v_mfma_f32_32x32x16_bf16 v[80:95], a[0:3], v[144:147], 0
    v_mfma_f32_32x32x16_bf16 v[80:95], a[4:7], v[148:151], v[80:95]
    v_add_u32 v180, s54, v176
    v_mfma_f32_32x32x16_bf16 v[80:95], a[8:11], v[152:155], v[80:95]
    v_add_u32 v181, s54, v177
    v_mfma_f32_32x32x16_bf16 v[80:95], a[12:15], v[156:159], v[80:95]
    v_add_u32 v182, s54, v178
    v_mfma_f32_32x32x16_bf16 v[80:95], a[16:19], v[160:163], v[80:95]
    v_add_u32 v183, s54, v179
    v_mfma_f32_32x32x16_bf16 v[80:95], a[20:23], v[164:167], v[80:95]
    s_add_u32 s54, s54, 8320
    v_mfma_f32_32x32x16_bf16 v[80:95], a[24:27], v[168:171], v[80:95]
    s_cmp_eq_u32 s54, 74880
    s_cselect_b32 s54, 0, s54
    v_mfma_f32_32x32x16_bf16 v[80:95], a[28:31], v[172:175], v[80:95]
    ds_read_b128 a[0:3], v180 offset:0
    ds_read_b128 a[4:7], v180 offset:32
    s_add_u32 s55, s55, 8320
    ds_read_b128 a[8:11], v181 offset:0
    ds_read_b128 a[12:15], v181 offset:32
    s_cmp_eq_u32 s55, 74880
    s_cselect_b32 s55, 0, s55
    ds_read_b128 a[16:19], v182 offset:0
    ds_read_b128 a[20:23], v182 offset:32
    v_add_u32 v188, s55, v184
    ds_read_b128 a[24:27], v183 offset:0
    v_add_u32 v189, s55, v185
    ds_read_b128 a[28:31], v183 offset:32
    v_add_u32 v190, s55, v186
    v_add_u32 v191, s55, v187
    s_nop 3
    v_max3_f32 v197, v80, v81, v82
    v_max3_f32 v197, v197, v83, v84
    v_max3_f32 v197, v197, v85, v86
    v_max3_f32 v197, v197, v87, v88
    v_max3_f32 v197, v197, v89, v90
    v_max3_f32 v197, v197, v91, v92
    v_max3_f32 v197, v197, v93, v94
    v_max_f32 v197, v197, v95
    v_mov_b32 v201, v197
    s_nop 1
    v_permlane32_swap_b32 v201, v197
    v_max_f32 v197, v201, v197
    v_sub_f32 v80, v80, v197
    v_sub_f32 v81, v81, v197
    v_sub_f32 v82, v82, v197
    v_sub_f32 v83, v83, v197
    v_sub_f32 v84, v84, v197
    v_sub_f32 v85, v85, v197
    v_sub_f32 v86, v86, v197
    v_sub_f32 v87, v87, v197
    v_sub_f32 v88, v88, v197
    v_sub_f32 v89, v89, v197
    v_sub_f32 v90, v90, v197
    v_sub_f32 v91, v91, v197
    v_sub_f32 v92, v92, v197
    v_sub_f32 v93, v93, v197
    v_sub_f32 v94, v94, v197
    v_sub_f32 v95, v95, v197
    v_sub_f32 v112, 0, v197
    v_sub_f32 v113, 0, v197
    v_sub_f32 v114, 0, v197
    v_sub_f32 v115, 0, v197
    v_sub_f32 v116, 0, v197
    v_sub_f32 v117, 0, v197
    v_sub_f32 v118, 0, v197
    v_sub_f32 v119, 0, v197
    v_sub_f32 v120, 0, v197
    v_sub_f32 v121, 0, v197
    v_sub_f32 v122, 0, v197
    v_sub_f32 v123, 0, v197
    v_sub_f32 v124, 0, v197
    v_sub_f32 v125, 0, v197
    v_sub_f32 v126, 0, v197
    v_sub_f32 v127, 0, v197
L_unit:
    v_mov_b32 v196, 0
    s_waitcnt lgkmcnt(0)
    s_barrier
    v_mfma_f32_32x32x16_bf16 v[96:111], a[0:3], v[144:147], v[112:127]
    v_exp_f32 v80, v80
    v_mfma_f32_32x32x16_bf16 v[96:111], a[4:7], v[148:151], v[96:111]
    v_exp_f32 v81, v81
    v_add_u32 v180, s54, v176
    v_add_f32 v196, v196, v80
    v_mfma_f32_32x32x16_bf16 v[96:111], a[8:11], v[152:155], v[96:111]
    v_exp_f32 v82, v82
    v_add_u32 v181, s54, v177
    v_add_f32 v196, v196, v81
    v_cvt_pk_bf16_f32 v128, v80, v81
    v_mfma_f32_32x32x16_bf16 v[96:111], a[12:15], v[156:159], v[96:111]
    v_exp_f32 v83, v83
    v_add_u32 v182, s54, v178
    v_add_f32 v196, v196, v82
    v_mfma_f32_32x32x16_bf16 v[96:111], a[16:19], v[160:163], v[96:111]
    v_exp_f32 v84, v84
    v_add_u32 v183, s54, v179
    v_add_f32 v196, v196, v83
    v_cvt_pk_bf16_f32 v129, v82, v83
    v_mfma_f32_32x32x16_bf16 v[96:111], a[20:23], v[164:167], v[96:111]
    v_exp_f32 v85, v85
    s_add_u32 s54, s54, 8320
    v_add_f32 v196, v196, v84
    v_mfma_f32_32x32x16_bf16 v[96:111], a[24:27], v[168:171], v[96:111]
    v_exp_f32 v86, v86
    s_cmp_eq_u32 s54, 74880
    s_cselect_b32 s54, 0, s54
    v_add_f32 v196, v196, v85
    v_cvt_pk_bf16_f32 v130, v84, v85
    v_mfma_f32_32x32x16_bf16 v[96:111], a[28:31], v[172:175], v[96:111]
    v_exp_f32 v87, v87
    v_add_f32 v196, v196, v86
    s_lshr_b32 s78, s78, 1
    v_mfma_f32_32x32x16_bf16 v[16:31], v[12:15], v[12:15], 0
    v_exp_f32 v88, v88
    ds_read_b128 a[0:3], v180 offset:0
    ds_read_b128 a[4:7], v180 offset:32
    v_add_f32 v196, v196, v87
    v_cvt_pk_bf16_f32 v131, v86, v87
    s_add_u32 s55, s55, 8320
    v_mfma_f32_32x32x16_bf16 v[32:47], v[12:15], v[12:15], 0
    v_exp_f32 v89, v89
    ds_read_b128 a[8:11], v181 offset:0
    ds_read_b128 a[12:15], v181 offset:32
    v_add_f32 v196, v196, v88
    s_cmp_eq_u32 s55, 74880
    s_cselect_b32 s55, 0, s55
    v_mfma_f32_32x32x16_bf16 v[48:63], v[12:15], v[12:15], 0
    v_exp_f32 v90, v90
    ds_read_b128 a[16:19], v182 offset:0
    ds_read_b128 a[20:23], v182 offset:32
    v_add_f32 v196, v196, v89
    v_cvt_pk_bf16_f32 v132, v88, v89
    v_add_u32 v188, s55, v184
    v_mfma_f32_32x32x16_bf16 v[64:79], v[12:15], v[12:15], 0
    v_exp_f32 v91, v91
    ds_read_b128 a[24:27], v183 offset:0
    v_add_f32 v196, v196, v90
    v_add_u32 v189, s55, v185
    v_max3_f32 v197, v96, v97, v98
    v_exp_f32 v92, v92
    ds_read_b128 a[28:31], v183 offset:32
    v_add_f32 v196, v196, v91
    v_cvt_pk_bf16_f32 v133, v90, v91
    v_add_u32 v190, s55, v186
    v_max3_f32 v197, v197, v99, v100
    v_exp_f32 v93, v93
    v_add_f32 v196, v196, v92
    v_add_u32 v191, s55, v187
    v_max3_f32 v197, v197, v101, v102
    v_max3_f32 v197, v197, v103, v104
    v_exp_f32 v94, v94
    v_add_f32 v196, v196, v93
    v_cvt_pk_bf16_f32 v134, v92, v93
    v_max3_f32 v197, v197, v105, v106
    v_max3_f32 v197, v197, v107, v108
    v_exp_f32 v95, v95
    v_add_f32 v196, v196, v94
    v_max3_f32 v197, v197, v109, v110
    v_max_f32 v197, v197, v111
    v_add_f32 v196, v196, v95
    v_cvt_pk_bf16_f32 v135, v94, v95
    v_cmp_lt_f32 vcc, s44, v197
    s_cbranch_vccnz L_rarea
L_rarea_ret:
    s_bitcmp1_b32 s78, 0
    s_cbranch_scc0 L_hra
    s_call_b64 s[40:41], L_hookc
L_hra:
    s_mov_b32 s45, 0
L_aloop:
    s_waitcnt lgkmcnt(0)
    s_barrier
    v_mfma_f32_32x32x16_bf16 v[80:95], a[0:3], v[144:147], v[112:127]
    v_exp_f32 v96, v96
    ds_read_b64_tr_b16 a[32:33], v188 offset:0
    ds_read_b64_tr_b16 a[34:35], v188 offset:2080
    v_mfma_f32_32x32x16_bf16 v[80:95], a[4:7], v[148:151], v[80:95]
    v_exp_f32 v97, v97
    ds_read_b64_tr_b16 a[36:37], v189 offset:0
    ds_read_b64_tr_b16 a[38:39], v189 offset:2080
    v_add_u32 v180, s54, v176
    v_add_f32 v196, v196, v96
    v_mfma_f32_32x32x16_bf16 v[80:95], a[8:11], v[152:155], v[80:95]
    v_exp_f32 v98, v98
    ds_read_b64_tr_b16 a[40:41], v190 offset:0
    ds_read_b64_tr_b16 a[42:43], v190 offset:2080
    v_add_u32 v181, s54, v177
    v_add_f32 v196, v196, v97
    v_cvt_pk_bf16_f32 v136, v96, v97
    v_mfma_f32_32x32x16_bf16 v[80:95], a[12:15], v[156:159], v[80:95]
    v_exp_f32 v99, v99
    ds_read_b64_tr_b16 a[44:45], v191 offset:0
    ds_read_b64_tr_b16 a[46:47], v191 offset:2080
    v_add_u32 v182, s54, v178
    v_add_f32 v196, v196, v98
    v_mfma_f32_32x32x16_bf16 v[80:95], a[16:19], v[160:163], v[80:95]
    v_exp_f32 v100, v100
    ds_read_b64_tr_b16 a[48:49], v188 offset:4160
    ds_read_b64_tr_b16 a[50:51], v188 offset:6240
    v_add_u32 v183, s54, v179
    v_add_f32 v196, v196, v99
    v_cvt_pk_bf16_f32 v137, v98, v99
    v_mfma_f32_32x32x16_bf16 v[80:95], a[20:23], v[164:167], v[80:95]
    v_exp_f32 v101, v101
    ds_read_b64_tr_b16 a[52:53], v189 offset:4160
    ds_read_b64_tr_b16 a[54:55], v189 offset:6240
    s_add_u32 s54, s54, 8320
    v_add_f32 v196, v196, v100
    v_mfma_f32_32x32x16_bf16 v[80:95], a[24:27], v[168:171], v[80:95]
    v_exp_f32 v102, v102
    ds_read_b64_tr_b16 a[56:57], v190 offset:4160
    ds_read_b64_tr_b16 a[58:59], v190 offset:6240
    s_cmp_eq_u32 s54, 74880
    s_cselect_b32 s54, 0, s54
    v_add_f32 v196, v196, v101
    v_cvt_pk_bf16_f32 v138, v100, v101
    v_mfma_f32_32x32x16_bf16 v[80:95], a[28:31], v[172:175], v[80:95]
    v_exp_f32 v103, v103
    ds_read_b64_tr_b16 a[60:61], v191 offset:4160
    ds_read_b64_tr_b16 a[62:63], v191 offset:6240
    v_add_f32 v196, v196, v102
    s_lshr_b32 s78, s78, 1
    s_waitcnt lgkmcnt(4)
    v_mfma_f32_32x32x16_bf16 v[16:31], a[32:35], v[128:131], v[16:31]
    v_exp_f32 v104, v104
    ds_read_b128 a[0:3], v180 offset:0
    ds_read_b128 a[4:7], v180 offset:32
    v_add_f32 v196, v196, v103
    v_cvt_pk_bf16_f32 v139, v102, v103
    s_add_u32 s55, s55, 8320
    v_mfma_f32_32x32x16_bf16 v[32:47], a[36:39], v[128:131], v[32:47]
    v_exp_f32 v105, v105
    ds_read_b128 a[8:11], v181 offset:0
    ds_read_b128 a[12:15], v181 offset:32
    v_add_f32 v196, v196, v104
    s_cmp_eq_u32 s55, 74880
    s_cselect_b32 s55, 0, s55
    v_mfma_f32_32x32x16_bf16 v[48:63], a[40:43], v[128:131], v[48:63]
    v_exp_f32 v106, v106
    ds_read_b128 a[16:19], v182 offset:0
    ds_read_b128 a[20:23], v182 offset:32
    v_add_f32 v196, v196, v105
    v_cvt_pk_bf16_f32 v140, v104, v105
    v_add_u32 v188, s55, v184
    v_mfma_f32_32x32x16_bf16 v[64:79], a[44:47], v[128:131], v[64:79]
    v_exp_f32 v107, v107
    ds_read_b128 a[24:27], v183 offset:0
    v_add_f32 v196, v196, v106
    v_add_u32 v189, s55, v185
    v_max3_f32 v197, v80, v81, v82
    v_mfma_f32_32x32x16_bf16 v[16:31], a[48:51], v[132:135], v[16:31]
    v_exp_f32 v108, v108
    ds_read_b128 a[28:31], v183 offset:32
    v_add_f32 v196, v196, v107
    v_cvt_pk_bf16_f32 v141, v106, v107
    v_add_u32 v190, s55, v186
    v_max3_f32 v197, v197, v83, v84
    v_mfma_f32_32x32x16_bf16 v[32:47], a[52:55], v[132:135], v[32:47]
    v_exp_f32 v109, v109
    v_add_f32 v196, v196, v108
    v_add_u32 v191, s55, v187
    v_max3_f32 v197, v197, v85, v86
    v_max3_f32 v197, v197, v87, v88
    s_waitcnt lgkmcnt(8)
    v_mfma_f32_32x32x16_bf16 v[48:63], a[56:59], v[132:135], v[48:63]
    v_exp_f32 v110, v110
    v_add_f32 v196, v196, v109
    v_cvt_pk_bf16_f32 v142, v108, v109
    v_max3_f32 v197, v197, v89, v90
    v_max3_f32 v197, v197, v91, v92
    v_mfma_f32_32x32x16_bf16 v[64:79], a[60:63], v[132:135], v[64:79]
    v_exp_f32 v111, v111
    v_add_f32 v196, v196, v110
    v_max3_f32 v197, v197, v93, v94
    v_max_f32 v197, v197, v95
    v_add_f32 v196, v196, v111
    v_cvt_pk_bf16_f32 v143, v110, v111
    v_cmp_lt_f32 vcc, s44, v197
    s_cbranch_vccnz L_rareb
L_rareb_ret:
    s_bitcmp1_b32 s78, 0
    s_cbranch_scc0 L_hrb
    s_call_b64 s[40:41], L_hookc
L_hrb:
    s_cmp_eq_u32 s45, s60
    s_cbranch_scc1 L_cd
    s_waitcnt lgkmcnt(0)
    s_barrier
    v_mfma_f32_32x32x16_bf16 v[96:111], a[0:3], v[144:147], v[112:127]
    v_exp_f32 v80, v80
    ds_read_b64_tr_b16 a[32:33], v188 offset:0
    ds_read_b64_tr_b16 a[34:35], v188 offset:2080
    v_mfma_f32_32x32x16_bf16 v[96:111], a[4:7], v[148:151], v[96:111]
    v_exp_f32 v81, v81
    ds_read_b64_tr_b16 a[36:37], v189 offset:0
    ds_read_b64_tr_b16 a[38:39], v189 offset:2080
    v_add_u32 v180, s54, v176
    v_add_f32 v196, v196, v80
    v_mfma_f32_32x32x16_bf16 v[96:111], a[8:11], v[152:155], v[96:111]
    v_exp_f32 v82, v82
    ds_read_b64_tr_b16 a[40:41], v190 offset:0
    ds_read_b64_tr_b16 a[42:43], v190 offset:2080
    v_add_u32 v181, s54, v177
    v_add_f32 v196, v196, v81
    v_cvt_pk_bf16_f32 v128, v80, v81
    v_mfma_f32_32x32x16_bf16 v[96:111], a[12:15], v[156:159], v[96:111]
    v_exp_f32 v83, v83
    ds_read_b64_tr_b16 a[44:45], v191 offset:0
    ds_read_b64_tr_b16 a[46:47], v191 offset:2080
    v_add_u32 v182, s54, v178
    v_add_f32 v196, v196, v82
    v_mfma_f32_32x32x16_bf16 v[96:111], a[16:19], v[160:163], v[96:111]
    v_exp_f32 v84, v84
    ds_read_b64_tr_b16 a[48:49], v188 offset:4160
    ds_read_b64_tr_b16 a[50:51], v188 offset:6240
    v_add_u32 v183, s54, v179
    v_add_f32 v196, v196, v83
    v_cvt_pk_bf16_f32 v129, v82, v83
    v_mfma_f32_32x32x16_bf16 v[96:111], a[20:23], v[164:167], v[96:111]
    v_exp_f32 v85, v85
    ds_read_b64_tr_b16 a[52:53], v189 offset:4160
    ds_read_b64_tr_b16 a[54:55], v189 offset:6240
    s_add_u32 s54, s54, 8320
    v_add_f32 v196, v196, v84
    v_mfma_f32_32x32x16_bf16 v[96:111], a[24:27], v[168:171], v[96:111]
    v_exp_f32 v86, v86
    ds_read_b64_tr_b16 a[56:57], v190 offset:4160
    ds_read_b64_tr_b16 a[58:59], v190 offset:6240
    s_cmp_eq_u32 s54, 74880
    s_cselect_b32 s54, 0, s54
    v_add_f32 v196, v196, v85
    v_cvt_pk_bf16_f32 v130, v84, v85
    v_mfma_f32_32x32x16_bf16 v[96:111], a[28:31], v[172:175], v[96:111]
    v_exp_f32 v87, v87
    ds_read_b64_tr_b16 a[60:61], v191 offset:4160
    ds_read_b64_tr_b16 a[62:63], v191 offset:6240
    v_add_f32 v196, v196, v86
    s_lshr_b32 s78, s78, 1
    s_waitcnt lgkmcnt(4)
    v_mfma_f32_32x32x16_bf16 v[16:31], a[32:35], v[136:139], v[16:31]
    v_exp_f32 v88, v88
    ds_read_b128 a[0:3], v180 offset:0
    ds_read_b128 a[4:7], v180 offset:32
    v_add_f32 v196, v196, v87
    v_cvt_pk_bf16_f32 v131, v86, v87
    s_add_u32 s55, s55, 8320
    v_mfma_f32_32x32x16_bf16 v[32:47], a[36:39], v[136:139], v[32:47]
    v_exp_f32 v89, v89
    ds_read_b128 a[8:11], v181 offset:0
    ds_read_b128 a[12:15], v181 offset:32
    v_add_f32 v196, v196, v88
    s_cmp_eq_u32 s55, 74880
    s_cselect_b32 s55, 0, s55
    v_mfma_f32_32x32x16_bf16 v[48:63], a[40:43], v[136:139], v[48:63]
    v_exp_f32 v90, v90
    ds_read_b128 a[16:19], v182 offset:0
    ds_read_b128 a[20:23], v182 offset:32
    v_add_f32 v196, v196, v89
    v_cvt_pk_bf16_f32 v132, v88, v89
    v_add_u32 v188, s55, v184
    v_mfma_f32_32x32x16_bf16 v[64:79], a[44:47], v[136:139], v[64:79]
    v_exp_f32 v91, v91
    ds_read_b128 a[24:27], v183 offset:0
    v_add_f32 v196, v196, v90
    v_add_u32 v189, s55, v185
    v_max3_f32 v197, v96, v97, v98
    v_mfma_f32_32x32x16_bf16 v[16:31], a[48:51], v[140:143], v[16:31]
    v_exp_f32 v92, v92
    ds_read_b128 a[28:31], v183 offset:32
    v_add_f32 v196, v196, v91
    v_cvt_pk_bf16_f32 v133, v90, v91
    v_add_u32 v190, s55, v186
    v_max3_f32 v197, v197, v99, v100
    v_mfma_f32_32x32x16_bf16 v[32:47], a[52:55], v[140:143], v[32:47]
    v_exp_f32 v93, v93
    v_add_f32 v196, v196, v92
    v_add_u32 v191, s55, v187
    v_max3_f32 v197, v197, v101, v102
    v_max3_f32 v197, v197, v103, v104
    s_waitcnt lgkmcnt(8)
    v_mfma_f32_32x32x16_bf16 v[48:63], a[56:59], v[140:143], v[48:63]
    v_exp_f32 v94, v94
    v_add_f32 v196, v196, v93
    v_cvt_pk_bf16_f32 v134, v92, v93
    v_max3_f32 v197, v197, v105, v106
    v_max3_f32 v197, v197, v107, v108
    v_mfma_f32_32x32x16_bf16 v[64:79], a[60:63], v[140:143], v[64:79]
    v_exp_f32 v95, v95
    v_add_f32 v196, v196, v94
    v_max3_f32 v197, v197, v109, v110
    v_max_f32 v197, v197, v111
    v_add_f32 v196, v196, v95
    v_cvt_pk_bf16_f32 v135, v94, v95
    v_cmp_lt_f32 vcc, s44, v197
    s_cbranch_vccnz L_rarec
L_rarec_ret:
    s_bitcmp1_b32 s78, 0
    s_cbranch_scc0 L_hrc
    s_call_b64 s[40:41], L_hookc
L_hrc:
L_ce:
    s_add_u32 s45, s45, 1
    s_cmp_lt_u32 s45, 7
    s_cbranch_scc1 L_aloop
L_pd:
    s_cmp_eq_u32 s39, 1
    s_cbranch_scc1 L_last
    s_waitcnt lgkmcnt(0)
    s_barrier
    v_mfma_f32_32x32x16_bf16 v[80:95], a[0:3], a[64:67], 0
    v_exp_f32 v96, v96
    ds_read_b64_tr_b16 a[32:33], v188 offset:0
    ds_read_b64_tr_b16 a[34:35], v188 offset:2080
    v_mfma_f32_32x32x16_bf16 v[80:95], a[4:7], a[68:71], v[80:95]
    v_exp_f32 v97, v97
    ds_read_b64_tr_b16 a[36:37], v189 offset:0
    ds_read_b64_tr_b16 a[38:39], v189 offset:2080
    v_add_u32 v180, s54, v176
    v_add_f32 v196, v196, v96
    v_mfma_f32_32x32x16_bf16 v[80:95], a[8:11], a[72:75], v[80:95]
    v_exp_f32 v98, v98
    ds_read_b64_tr_b16 a[40:41], v190 offset:0
    ds_read_b64_tr_b16 a[42:43], v190 offset:2080
    v_add_u32 v181, s54, v177
    v_add_f32 v196, v196, v97
    v_cvt_pk_bf16_f32 v136, v96, v97
    v_mfma_f32_32x32x16_bf16 v[80:95], a[12:15], a[76:79], v[80:95]
    v_exp_f32 v99, v99
    ds_read_b64_tr_b16 a[44:45], v191 offset:0
    ds_read_b64_tr_b16 a[46:47], v191 offset:2080
    v_add_u32 v182, s54, v178
    v_add_f32 v196, v196, v98
    v_mfma_f32_32x32x16_bf16 v[80:95], a[16:19], a[80:83], v[80:95]
    v_exp_f32 v100, v100
    ds_read_b64_tr_b16 a[48:49], v188 offset:4160
    ds_read_b64_tr_b16 a[50:51], v188 offset:6240
    v_add_u32 v183, s54, v179
    v_add_f32 v196, v196, v99
    v_cvt_pk_bf16_f32 v137, v98, v99
    v_mfma_f32_32x32x16_bf16 v[80:95], a[20:23], a[84:87], v[80:95]
    v_exp_f32 v101, v101
    ds_read_b64_tr_b16 a[52:53], v189 offset:4160
    ds_read_b64_tr_b16 a[54:55], v189 offset:6240
    s_add_u32 s54, s54, 8320
    v_add_f32 v196, v196, v100
    v_mfma_f32_32x32x16_bf16 v[80:95], a[24:27], a[88:91], v[80:95]
    v_exp_f32 v102, v102
    ds_read_b64_tr_b16 a[56:57], v190 offset:4160
    ds_read_b64_tr_b16 a[58:59], v190 offset:6240
    s_cmp_eq_u32 s54, 74880
    s_cselect_b32 s54, 0, s54
    v_add_f32 v196, v196, v101
    v_cvt_pk_bf16_f32 v138, v100, v101
    v_mfma_f32_32x32x16_bf16 v[80:95], a[28:31], a[92:95], v[80:95]
    v_exp_f32 v103, v103
    ds_read_b64_tr_b16 a[60:61], v191 offset:4160
    ds_read_b64_tr_b16 a[62:63], v191 offset:6240
    v_add_f32 v196, v196, v102
    s_waitcnt lgkmcnt(4)
    v_mfma_f32_32x32x16_bf16 v[16:31], a[32:35], v[128:131], v[16:31]
    v_exp_f32 v104, v104
    ds_read_b128 a[0:3], v180 offset:0
    ds_read_b128 a[4:7], v180 offset:32
    v_add_f32 v196, v196, v103
    v_cvt_pk_bf16_f32 v139, v102, v103
    s_add_u32 s55, s55, 8320
    v_mfma_f32_32x32x16_bf16 v[32:47], a[36:39], v[128:131], v[32:47]
    v_exp_f32 v105, v105
    ds_read_b128 a[8:11], v181 offset:0
    ds_read_b128 a[12:15], v181 offset:32
    v_add_f32 v196, v196, v104
    s_cmp_eq_u32 s55, 74880
    s_cselect_b32 s55, 0, s55
    v_mfma_f32_32x32x16_bf16 v[48:63], a[40:43], v[128:131], v[48:63]
    v_exp_f32 v106, v106
    ds_read_b128 a[16:19], v182 offset:0
    ds_read_b128 a[20:23], v182 offset:32
    v_add_f32 v196, v196, v105
    v_cvt_pk_bf16_f32 v140, v104, v105
    v_add_u32 v188, s55, v184
    v_mfma_f32_32x32x16_bf16 v[64:79], a[44:47], v[128:131], v[64:79]
    v_exp_f32 v107, v107
    ds_read_b128 a[24:27], v183 offset:0
    v_add_f32 v196, v196, v106
    v_add_u32 v189, s55, v185
    v_mfma_f32_32x32x16_bf16 v[16:31], a[48:51], v[132:135], v[16:31]
    v_exp_f32 v108, v108
    ds_read_b128 a[28:31], v183 offset:32
    v_add_f32 v196, v196, v107
    v_cvt_pk_bf16_f32 v141, v106, v107
    v_add_u32 v190, s55, v186
    v_mfma_f32_32x32x16_bf16 v[32:47], a[52:55], v[132:135], v[32:47]
    v_exp_f32 v109, v109
    v_add_f32 v196, v196, v108
    v_add_u32 v191, s55, v187
    s_waitcnt lgkmcnt(8)
    v_mfma_f32_32x32x16_bf16 v[48:63], a[56:59], v[132:135], v[48:63]
    v_exp_f32 v110, v110
    v_add_f32 v196, v196, v109
    v_cvt_pk_bf16_f32 v142, v108, v109
    v_mfma_f32_32x32x16_bf16 v[64:79], a[60:63], v[132:135], v[64:79]
    v_exp_f32 v111, v111
    v_add_f32 v196, v196, v110
    s_nop 0
    v_add_f32 v196, v196, v111
    v_cvt_pk_bf16_f32 v143, v110, v111
    ds_read_b32 v200, v211 offset:8
    s_waitcnt lgkmcnt(0)
    s_barrier
    ds_read_b64_tr_b16 a[32:33], v188 offset:0
    ds_read_b64_tr_b16 a[34:35], v188 offset:2080
    v_max3_f32 v197, v80, v81, v82
    v_max3_f32 v197, v197, v83, v84
    ds_read_b64_tr_b16 a[36:37], v189 offset:0
    ds_read_b64_tr_b16 a[38:39], v189 offset:2080
    v_max3_f32 v197, v197, v85, v86
    v_max3_f32 v197, v197, v87, v88
    ds_read_b64_tr_b16 a[40:41], v190 offset:0
    ds_read_b64_tr_b16 a[42:43], v190 offset:2080
    v_max3_f32 v197, v197, v89, v90
    v_max3_f32 v197, v197, v91, v92
    ds_read_b64_tr_b16 a[44:45], v191 offset:0
    ds_read_b64_tr_b16 a[46:47], v191 offset:2080
    v_max3_f32 v197, v197, v93, v94
    v_max_f32 v197, v197, v95
    ds_read_b64_tr_b16 a[48:49], v188 offset:4160
    ds_read_b64_tr_b16 a[50:51], v188 offset:6240
    v_mov_b32 v201, v197
    s_nop 1
    v_permlane32_swap_b32 v201, v197
    v_max_f32 v197, v201, v197
    ds_read_b64_tr_b16 a[52:53], v189 offset:4160
    ds_read_b64_tr_b16 a[54:55], v189 offset:6240
    v_sub_f32 v80, v80, v197
    v_sub_f32 v81, v81, v197
    v_sub_f32 v82, v82, v197
    ds_read_b64_tr_b16 a[56:57], v190 offset:4160
    ds_read_b64_tr_b16 a[58:59], v190 offset:6240
    v_sub_f32 v83, v83, v197
    v_sub_f32 v84, v84, v197
    v_sub_f32 v85, v85, v197
    ds_read_b64_tr_b16 a[60:61], v191 offset:4160
    ds_read_b64_tr_b16 a[62:63], v191 offset:6240
    v_sub_f32 v86, v86, v197
    v_sub_f32 v87, v87, v197
    s_waitcnt lgkmcnt(4)
    v_mfma_f32_32x32x16_bf16 v[16:31], a[32:35], v[136:139], v[16:31]
    v_sub_f32 v88, v88, v197
    v_sub_f32 v89, v89, v197
    v_sub_f32 v90, v90, v197
    v_sub_f32 v91, v91, v197
    v_sub_f32 v92, v92, v197
    v_sub_f32 v93, v93, v197
    v_sub_f32 v94, v94, v197
    v_mfma_f32_32x32x16_bf16 v[32:47], a[36:39], v[136:139], v[32:47]
    v_sub_f32 v95, v95, v197
    v_sub_f32 v112, 0, v197
    v_sub_f32 v113, 0, v197
    v_sub_f32 v114, 0, v197
    v_sub_f32 v115, 0, v197
    v_sub_f32 v116, 0, v197
    v_sub_f32 v117, 0, v197
    v_mfma_f32_32x32x16_bf16 v[48:63], a[40:43], v[136:139], v[48:63]
    v_sub_f32 v118, 0, v197
    v_sub_f32 v119, 0, v197
    v_sub_f32 v120, 0, v197
    v_sub_f32 v121, 0, v197
    v_sub_f32 v122, 0, v197
    v_sub_f32 v123, 0, v197
    v_sub_f32 v124, 0, v197
    v_mfma_f32_32x32x16_bf16 v[64:79], a[44:47], v[136:139], v[64:79]
    v_sub_f32 v125, 0, v197
    v_sub_f32 v126, 0, v197
    v_sub_f32 v127, 0, v197
    v_accvgpr_read_b32 v144, a64
    v_accvgpr_read_b32 v145, a65
    v_accvgpr_read_b32 v146, a66
    v_accvgpr_read_b32 v147, a67
    v_mfma_f32_32x32x16_bf16 v[16:31], a[48:51], v[140:143], v[16:31]
    v_accvgpr_read_b32 v148, a68
    v_accvgpr_read_b32 v149, a69
    v_accvgpr_read_b32 v150, a70
    v_accvgpr_read_b32 v151, a71
    v_accvgpr_read_b32 v152, a72
    v_accvgpr_read_b32 v153, a73
    v_accvgpr_read_b32 v154, a74
    v_mfma_f32_32x32x16_bf16 v[32:47], a[52:55], v[140:143], v[32:47]
    v_accvgpr_read_b32 v155, a75
    v_accvgpr_read_b32 v156, a76
    v_accvgpr_read_b32 v157, a77
    v_accvgpr_read_b32 v158, a78
    v_accvgpr_read_b32 v159, a79
    v_accvgpr_read_b32 v160, a80
    v_accvgpr_read_b32 v161, a81
    s_waitcnt lgkmcnt(0)
    v_mfma_f32_32x32x16_bf16 v[48:63], a[56:59], v[140:143], v[48:63]
    v_accvgpr_read_b32 v162, a82
    v_accvgpr_read_b32 v163, a83
    v_accvgpr_read_b32 v164, a84
    v_accvgpr_read_b32 v165, a85
    v_accvgpr_read_b32 v166, a86
    v_accvgpr_read_b32 v167, a87
    v_accvgpr_read_b32 v168, a88
    v_mfma_f32_32x32x16_bf16 v[64:79], a[60:63], v[140:143], v[64:79]
    v_accvgpr_read_b32 v169, a89
    v_accvgpr_read_b32 v170, a90
    v_accvgpr_read_b32 v171, a91
    v_accvgpr_read_b32 v172, a92
    v_accvgpr_read_b32 v173, a93
    v_accvgpr_read_b32 v174, a94
    v_accvgpr_read_b32 v175, a95
    s_branch L_fin
L_last:
    s_waitcnt lgkmcnt(0)
    s_barrier
    v_exp_f32 v96, v96
    ds_read_b64_tr_b16 a[32:33], v188 offset:0
    ds_read_b64_tr_b16 a[34:35], v188 offset:2080
    v_exp_f32 v97, v97
    ds_read_b64_tr_b16 a[36:37], v189 offset:0
    ds_read_b64_tr_b16 a[38:39], v189 offset:2080
    v_add_f32 v196, v196, v96
    v_exp_f32 v98, v98
    ds_read_b64_tr_b16 a[40:41], v190 offset:0
    ds_read_b64_tr_b16 a[42:43], v190 offset:2080
    v_add_f32 v196, v196, v97
    v_cvt_pk_bf16_f32 v136, v96, v97
    v_exp_f32 v99, v99
    ds_read_b64_tr_b16 a[44:45], v191 offset:0
    ds_read_b64_tr_b16 a[46:47], v191 offset:2080
    v_add_f32 v196, v196, v98
    v_exp_f32 v100, v100
    ds_read_b64_tr_b16 a[48:49], v188 offset:4160
    ds_read_b64_tr_b16 a[50:51], v188 offset:6240
    v_add_f32 v196, v196, v99
    v_cvt_pk_bf16_f32 v137, v98, v99
    v_exp_f32 v101, v101
    ds_read_b64_tr_b16 a[52:53], v189 offset:4160
    ds_read_b64_tr_b16 a[54:55], v189 offset:6240
    v_add_f32 v196, v196, v100
    v_exp_f32 v102, v102
    ds_read_b64_tr_b16 a[56:57], v190 offset:4160
    ds_read_b64_tr_b16 a[58:59], v190 offset:6240
    v_add_f32 v196, v196, v101
    v_cvt_pk_bf16_f32 v138, v100, v101
    v_exp_f32 v103, v103
    ds_read_b64_tr_b16 a[60:61], v191 offset:4160
    ds_read_b64_tr_b16 a[62:63], v191 offset:6240
    v_add_f32 v196, v196, v102
    s_waitcnt lgkmcnt(4)
    v_mfma_f32_32x32x16_bf16 v[16:31], a[32:35], v[128:131], v[16:31]
    v_exp_f32 v104, v104
    v_add_f32 v196, v196, v103
    v_cvt_pk_bf16_f32 v139, v102, v103
    s_add_u32 s55, s55, 8320
    v_mfma_f32_32x32x16_bf16 v[32:47], a[36:39], v[128:131], v[32:47]
    v_exp_f32 v105, v105
    v_add_f32 v196, v196, v104
    s_cmp_eq_u32 s55, 74880
    s_cselect_b32 s55, 0, s55
    v_mfma_f32_32x32x16_bf16 v[48:63], a[40:43], v[128:131], v[48:63]
    v_exp_f32 v106, v106
    v_add_f32 v196, v196, v105
    v_cvt_pk_bf16_f32 v140, v104, v105
    v_add_u32 v188, s55, v184
    v_mfma_f32_32x32x16_bf16 v[64:79], a[44:47], v[128:131], v[64:79]
    v_exp_f32 v107, v107
    v_add_f32 v196, v196, v106
    v_add_u32 v189, s55, v185
    v_mfma_f32_32x32x16_bf16 v[16:31], a[48:51], v[132:135], v[16:31]
    v_exp_f32 v108, v108
    v_add_f32 v196, v196, v107
    v_cvt_pk_bf16_f32 v141, v106, v107
    v_add_u32 v190, s55, v186
    v_mfma_f32_32x32x16_bf16 v[32:47], a[52:55], v[132:135], v[32:47]
    v_exp_f32 v109, v109
    v_add_f32 v196, v196, v108
    v_add_u32 v191, s55, v187
    s_waitcnt lgkmcnt(0)
    v_mfma_f32_32x32x16_bf16 v[48:63], a[56:59], v[132:135], v[48:63]
    v_exp_f32 v110, v110
    v_add_f32 v196, v196, v109
    v_cvt_pk_bf16_f32 v142, v108, v109
    v_mfma_f32_32x32x16_bf16 v[64:79], a[60:63], v[132:135], v[64:79]
    v_exp_f32 v111, v111
    v_add_f32 v196, v196, v110
    s_nop 0
    v_add_f32 v196, v196, v111
    v_cvt_pk_bf16_f32 v143, v110, v111
    ds_read_b32 v200, v211 offset:8
    s_waitcnt lgkmcnt(0)
    s_barrier
    ds_read_b64_tr_b16 a[32:33], v188 offset:0
    ds_read_b64_tr_b16 a[34:35], v188 offset:2080
    ds_read_b64_tr_b16 a[36:37], v189 offset:0
    ds_read_b64_tr_b16 a[38:39], v189 offset:2080
    ds_read_b64_tr_b16 a[40:41], v190 offset:0
    ds_read_b64_tr_b16 a[42:43], v190 offset:2080
    ds_read_b64_tr_b16 a[44:45], v191 offset:0
    ds_read_b64_tr_b16 a[46:47], v191 offset:2080
    ds_read_b64_tr_b16 a[48:49], v188 offset:4160
    ds_read_b64_tr_b16 a[50:51], v188 offset:6240
    ds_read_b64_tr_b16 a[52:53], v189 offset:4160
    ds_read_b64_tr_b16 a[54:55], v189 offset:6240
    ds_read_b64_tr_b16 a[56:57], v190 offset:4160
    ds_read_b64_tr_b16 a[58:59], v190 offset:6240
    ds_read_b64_tr_b16 a[60:61], v191 offset:4160
    ds_read_b64_tr_b16 a[62:63], v191 offset:6240
    s_waitcnt lgkmcnt(4)
    v_mfma_f32_32x32x16_bf16 v[16:31], a[32:35], v[136:139], v[16:31]
    v_mfma_f32_32x32x16_bf16 v[32:47], a[36:39], v[136:139], v[32:47]
    v_mfma_f32_32x32x16_bf16 v[48:63], a[40:43], v[136:139], v[48:63]
    v_mfma_f32_32x32x16_bf16 v[64:79], a[44:47], v[136:139], v[64:79]
    v_mfma_f32_32x32x16_bf16 v[16:31], a[48:51], v[140:143], v[16:31]
    v_mfma_f32_32x32x16_bf16 v[32:47], a[52:55], v[140:143], v[32:47]
    s_waitcnt lgkmcnt(0)
    v_mfma_f32_32x32x16_bf16 v[48:63], a[56:59], v[140:143], v[48:63]
    v_mfma_f32_32x32x16_bf16 v[64:79], a[60:63], v[140:143], v[64:79]
L_fin:
    v_mov_b32 v198, v196
    s_nop 1
    v_permlane32_swap_b32 v198, v196
    v_add_f32 v196, v198, v196
    v_rcp_f32 v198, v196
    s_mul_i32 s46, s38, 3
    s_add_u32 s46, s46, s36
    s_lshl_b32 s46, s46, 1
    s_add_u32 s46, s46, s39
    s_lshl_b32 s46, s46, 4
    s_add_u32 s46, s46, s37
    s_lshl_b32 s46, s46, 13
    v_readfirstlane_b32 s49, v200
    v_mov_b32 v199, v198
    s_nop 2
    s_cmp_eq_u32 s49, 32
    s_cbranch_scc0 L_fins
    v_pk_mul_f32 v[16:17], v[16:17], v[198:199]
    v_pk_mul_f32 v[18:19], v[18:19], v[198:199]
    v_pk_mul_f32 v[20:21], v[20:21], v[198:199]
    v_pk_mul_f32 v[22:23], v[22:23], v[198:199]
    v_pk_mul_f32 v[24:25], v[24:25], v[198:199]
    v_pk_mul_f32 v[26:27], v[26:27], v[198:199]
    v_pk_mul_f32 v[28:29], v[28:29], v[198:199]
    v_pk_mul_f32 v[30:31], v[30:31], v[198:199]
    v_cvt_pk_bf16_f32 v96, v16, v17
    v_cvt_pk_bf16_f32 v97, v18, v19
    v_cvt_pk_bf16_f32 v98, v20, v21
    v_cvt_pk_bf16_f32 v99, v22, v23
    v_cvt_pk_bf16_f32 v100, v24, v25
    v_cvt_pk_bf16_f32 v101, v26, v27
    v_cvt_pk_bf16_f32 v102, v28, v29
    v_cvt_pk_bf16_f32 v103, v30, v31
    buffer_store_dwordx4 v[96:99], v2, s[20:23], s46 offen offset:0
    buffer_store_dwordx4 v[100:103], v2, s[20:23], s46 offen offset:1024
    v_pk_mul_f32 v[32:33], v[32:33], v[198:199]
    v_pk_mul_f32 v[34:35], v[34:35], v[198:199]
    v_pk_mul_f32 v[36:37], v[36:37], v[198:199]
    v_pk_mul_f32 v[38:39], v[38:39], v[198:199]
    v_pk_mul_f32 v[40:41], v[40:41], v[198:199]
    v_pk_mul_f32 v[42:43], v[42:43], v[198:199]
    v_pk_mul_f32 v[44:45], v[44:45], v[198:199]
    v_pk_mul_f32 v[46:47], v[46:47], v[198:199]
    v_cvt_pk_bf16_f32 v104, v32, v33
    v_cvt_pk_bf16_f32 v105, v34, v35
    v_cvt_pk_bf16_f32 v106, v36, v37
    v_cvt_pk_bf16_f32 v107, v38, v39
    v_cvt_pk_bf16_f32 v108, v40, v41
    v_cvt_pk_bf16_f32 v109, v42, v43
    v_cvt_pk_bf16_f32 v110, v44, v45
    v_cvt_pk_bf16_f32 v111, v46, v47
    buffer_store_dwordx4 v[104:107], v2, s[20:23], s46 offen offset:2048
    buffer_store_dwordx4 v[108:111], v2, s[20:23], s46 offen offset:3072
    v_pk_mul_f32 v[48:49], v[48:49], v[198:199]
    v_pk_mul_f32 v[50:51], v[50:51], v[198:199]
    v_pk_mul_f32 v[52:53], v[52:53], v[198:199]
    v_pk_mul_f32 v[54:55], v[54:55], v[198:199]
    v_pk_mul_f32 v[56:57], v[56:57], v[198:199]
    v_pk_mul_f32 v[58:59], v[58:59], v[198:199]
    v_pk_mul_f32 v[60:61], v[60:61], v[198:199]
    v_pk_mul_f32 v[62:63], v[62:63], v[198:199]
    v_cvt_pk_bf16_f32 v128, v48, v49
    v_cvt_pk_bf16_f32 v129, v50, v51
    v_cvt_pk_bf16_f32 v130, v52, v53
    v_cvt_pk_bf16_f32 v131, v54, v55
    v_cvt_pk_bf16_f32 v132, v56, v57
    v_cvt_pk_bf16_f32 v133, v58, v59
    v_cvt_pk_bf16_f32 v134, v60, v61
    v_cvt_pk_bf16_f32 v135, v62, v63
    buffer_store_dwordx4 v[128:131], v3, s[20:23], s46 offen offset:0
    buffer_store_dwordx4 v[132:135], v3, s[20:23], s46 offen offset:1024
    v_pk_mul_f32 v[64:65], v[64:65], v[198:199]
    v_pk_mul_f32 v[66:67], v[66:67], v[198:199]
    v_pk_mul_f32 v[68:69], v[68:69], v[198:199]
    v_pk_mul_f32 v[70:71], v[70:71], v[198:199]
    v_pk_mul_f32 v[72:73], v[72:73], v[198:199]
    v_pk_mul_f32 v[74:75], v[74:75], v[198:199]
    v_pk_mul_f32 v[76:77], v[76:77], v[198:199]
    v_pk_mul_f32 v[78:79], v[78:79], v[198:199]
    v_cvt_pk_bf16_f32 v136, v64, v65
    v_cvt_pk_bf16_f32 v137, v66, v67
    v_cvt_pk_bf16_f32 v138, v68, v69
    v_cvt_pk_bf16_f32 v139, v70, v71
    v_cvt_pk_bf16_f32 v140, v72, v73
    v_cvt_pk_bf16_f32 v141, v74, v75
    v_cvt_pk_bf16_f32 v142, v76, v77
    v_cvt_pk_bf16_f32 v143, v78, v79
    buffer_store_dwordx4 v[136:139], v3, s[20:23], s46 offen offset:2048
    buffer_store_dwordx4 v[140:143], v3, s[20:23], s46 offen offset:3072
L_finr:
    s_cmp_eq_u32 s39, 1
    s_cbranch_scc1 L_tail
    s_mov_b32 s39, 1
    s_mov_b32 s55, 33280
    ds_read_b32 v209, v211
    s_mov_b32 s78, -1
    v_add_u32 v4, s61, v2
    v_add_u32 v5, s61, v3
    v_add_u32 v7, 0x20000, v4
    v_add_u32 v8, 0x20000, v5
    s_branch L_unit
L_cd:
    s_cmp_eq_u32 s45, 0
    s_cbranch_scc0 L_cd1
    s_waitcnt lgkmcnt(0)
    s_barrier
    v_mfma_f32_32x32x16_bf16 v[96:111], a[0:3], v[144:147], v[112:127]
    v_exp_f32 v80, v80
    ds_read_b64_tr_b16 a[32:33], v188 offset:0
    ds_read_b64_tr_b16 a[34:35], v188 offset:2080
    v_add_u32 v198, s77, v2
    v_mfma_f32_32x32x16_bf16 v[96:111], a[4:7], v[148:151], v[96:111]
    v_exp_f32 v81, v81
    ds_read_b64_tr_b16 a[36:37], v189 offset:0
    ds_read_b64_tr_b16 a[38:39], v189 offset:2080
    v_add_u32 v180, s54, v176
    v_add_f32 v196, v196, v80
    v_mfma_f32_32x32x16_bf16 v[96:111], a[8:11], v[152:155], v[96:111]
    v_exp_f32 v82, v82
    ds_read_b64_tr_b16 a[40:41], v190 offset:0
    ds_read_b64_tr_b16 a[42:43], v190 offset:2080
    v_add_u32 v181, s54, v177
    s_add_u32 s77, s77, 24960
    v_add_f32 v196, v196, v81
    v_cvt_pk_bf16_f32 v128, v80, v81
    v_mfma_f32_32x32x16_bf16 v[96:111], a[12:15], v[156:159], v[96:111]
    v_exp_f32 v83, v83
    ds_read_b64_tr_b16 a[44:45], v191 offset:0
    ds_read_b64_tr_b16 a[46:47], v191 offset:2080
    v_add_u32 v182, s54, v178
    s_cmp_ge_u32 s77, s58
    s_cselect_b32 s46, 74880, 0
    v_add_f32 v196, v196, v82
    v_mfma_f32_32x32x16_bf16 v[96:111], a[16:19], v[160:163], v[96:111]
    v_exp_f32 v84, v84
    ds_read_b64_tr_b16 a[48:49], v188 offset:4160
    ds_read_b64_tr_b16 a[50:51], v188 offset:6240
    v_add_u32 v183, s54, v179
    s_sub_u32 s77, s77, s46
    s_mov_b32 s60, 1
    v_add_f32 v196, v196, v83
    v_cvt_pk_bf16_f32 v129, v82, v83
    v_mfma_f32_32x32x16_bf16 v[96:111], a[20:23], v[164:167], v[96:111]
    v_exp_f32 v85, v85
    ds_read_b64_tr_b16 a[52:53], v189 offset:4160
    ds_read_b64_tr_b16 a[54:55], v189 offset:6240
    s_add_u32 s54, s54, 8320
    v_add_f32 v196, v196, v84
    v_mfma_f32_32x32x16_bf16 v[96:111], a[24:27], v[168:171], v[96:111]
    v_exp_f32 v86, v86
    ds_read_b64_tr_b16 a[56:57], v190 offset:4160
    ds_read_b64_tr_b16 a[58:59], v190 offset:6240
    s_cmp_eq_u32 s54, 74880
    s_cselect_b32 s54, 0, s54
    v_add_f32 v196, v196, v85
    v_cvt_pk_bf16_f32 v130, v84, v85
    v_mfma_f32_32x32x16_bf16 v[96:111], a[28:31], v[172:175], v[96:111]
    v_exp_f32 v87, v87
    ds_read_b64_tr_b16 a[60:61], v191 offset:4160
    ds_read_b64_tr_b16 a[62:63], v191 offset:6240
    s_waitcnt vmcnt(0)
    v_add_f32 v196, v196, v86
    s_waitcnt lgkmcnt(4)
    v_mfma_f32_32x32x16_bf16 v[16:31], a[32:35], v[136:139], v[16:31]
    v_exp_f32 v88, v88
    ds_read_b128 a[0:3], v180 offset:0
    ds_read_b128 a[4:7], v180 offset:32
    ds_write_b128 v198, a[96:99] offset:0
    v_add_f32 v196, v196, v87
    v_cvt_pk_bf16_f32 v131, v86, v87
    s_add_u32 s55, s55, 8320
    v_mfma_f32_32x32x16_bf16 v[32:47], a[36:39], v[136:139], v[32:47]
    v_exp_f32 v89, v89
    ds_read_b128 a[8:11], v181 offset:0
    ds_read_b128 a[12:15], v181 offset:32
    ds_write_b128 v198, a[100:103] offset:1040
    v_add_f32 v196, v196, v88
    s_cmp_eq_u32 s55, 74880
    s_cselect_b32 s55, 0, s55
    v_mfma_f32_32x32x16_bf16 v[48:63], a[40:43], v[136:139], v[48:63]
    v_exp_f32 v90, v90
    ds_read_b128 a[16:19], v182 offset:0
    ds_read_b128 a[20:23], v182 offset:32
    ds_write_b128 v198, a[104:107] offset:2080
    v_add_f32 v196, v196, v89
    v_cvt_pk_bf16_f32 v132, v88, v89
    v_add_u32 v188, s55, v184
    v_mfma_f32_32x32x16_bf16 v[64:79], a[44:47], v[136:139], v[64:79]
    v_exp_f32 v91, v91
    ds_read_b128 a[24:27], v183 offset:0
    ds_write_b128 v198, a[108:111] offset:3120
    v_add_f32 v196, v196, v90
    v_add_u32 v189, s55, v185
    v_max3_f32 v197, v96, v97, v98
    v_mfma_f32_32x32x16_bf16 v[16:31], a[48:51], v[140:143], v[16:31]
    v_exp_f32 v92, v92
    ds_read_b128 a[28:31], v183 offset:32
    ds_write_b128 v198, a[112:115] offset:4160
    v_add_f32 v196, v196, v91
    v_cvt_pk_bf16_f32 v133, v90, v91
    v_add_u32 v190, s55, v186
    v_max3_f32 v197, v197, v99, v100
    v_mfma_f32_32x32x16_bf16 v[32:47], a[52:55], v[140:143], v[32:47]
    v_exp_f32 v93, v93
    ds_write_b128 v198, a[116:119] offset:5200
    v_add_f32 v196, v196, v92
    v_add_u32 v191, s55, v187
    v_max3_f32 v197, v197, v101, v102
    v_max3_f32 v197, v197, v103, v104
    s_waitcnt lgkmcnt(14)
    v_mfma_f32_32x32x16_bf16 v[48:63], a[56:59], v[140:143], v[48:63]
    v_exp_f32 v94, v94
    ds_write_b128 v198, a[120:123] offset:6240
    v_add_f32 v196, v196, v93
    v_cvt_pk_bf16_f32 v134, v92, v93
    v_max3_f32 v197, v197, v105, v106
    v_max3_f32 v197, v197, v107, v108
    v_mfma_f32_32x32x16_bf16 v[64:79], a[60:63], v[140:143], v[64:79]
    v_exp_f32 v95, v95
    ds_write_b128 v198, a[124:127] offset:7280
    v_add_f32 v196, v196, v94
    v_max3_f32 v197, v197, v109, v110
    v_max_f32 v197, v197, v111
    v_add_f32 v196, v196, v95
    v_cvt_pk_bf16_f32 v135, v94, v95
    v_cmp_lt_f32 vcc, s44, v197
    s_cbranch_vccnz L_rareh0
L_rareh0_ret:
    s_branch L_ce
L_cd1:
    s_cmp_eq_u32 s45, 1
    s_cbranch_scc0 L_cd2
    s_waitcnt lgkmcnt(0)
    s_barrier
    v_mfma_f32_32x32x16_bf16 v[96:111], a[0:3], v[144:147], v[112:127]
    v_exp_f32 v80, v80
    ds_read_b64_tr_b16 a[32:33], v188 offset:0
    ds_read_b64_tr_b16 a[34:35], v188 offset:2080
    v_add_u32 v198, s77, v2
    v_mfma_f32_32x32x16_bf16 v[96:111], a[4:7], v[148:151], v[96:111]
    v_exp_f32 v81, v81
    ds_read_b64_tr_b16 a[36:37], v189 offset:0
    ds_read_b64_tr_b16 a[38:39], v189 offset:2080
    v_add_u32 v180, s54, v176
    v_add_f32 v196, v196, v80
    v_mfma_f32_32x32x16_bf16 v[96:111], a[8:11], v[152:155], v[96:111]
    v_exp_f32 v82, v82
    ds_read_b64_tr_b16 a[40:41], v190 offset:0
    ds_read_b64_tr_b16 a[42:43], v190 offset:2080
    v_add_u32 v181, s54, v177
    s_add_u32 s77, s77, 24960
    v_add_f32 v196, v196, v81
    v_cvt_pk_bf16_f32 v128, v80, v81
    v_mfma_f32_32x32x16_bf16 v[96:111], a[12:15], v[156:159], v[96:111]
    v_exp_f32 v83, v83
    ds_read_b64_tr_b16 a[44:45], v191 offset:0
    ds_read_b64_tr_b16 a[46:47], v191 offset:2080
    v_add_u32 v182, s54, v178
    s_cmp_ge_u32 s77, s58
    s_cselect_b32 s46, 74880, 0
    v_add_f32 v196, v196, v82
    v_mfma_f32_32x32x16_bf16 v[96:111], a[16:19], v[160:163], v[96:111]
    v_exp_f32 v84, v84
    ds_read_b64_tr_b16 a[48:49], v188 offset:4160
    ds_read_b64_tr_b16 a[50:51], v188 offset:6240
    v_add_u32 v183, s54, v179
    s_sub_u32 s77, s77, s46
    s_mov_b32 s60, 3
    v_add_f32 v196, v196, v83
    v_cvt_pk_bf16_f32 v129, v82, v83
    v_mfma_f32_32x32x16_bf16 v[96:111], a[20:23], v[164:167], v[96:111]
    v_exp_f32 v85, v85
    ds_read_b64_tr_b16 a[52:53], v189 offset:4160
    ds_read_b64_tr_b16 a[54:55], v189 offset:6240
    s_add_u32 s54, s54, 8320
    v_add_f32 v196, v196, v84
    v_mfma_f32_32x32x16_bf16 v[96:111], a[24:27], v[168:171], v[96:111]
    v_exp_f32 v86, v86
    ds_read_b64_tr_b16 a[56:57], v190 offset:4160
    ds_read_b64_tr_b16 a[58:59], v190 offset:6240
    s_cmp_eq_u32 s54, 74880
    s_cselect_b32 s54, 0, s54
    v_add_f32 v196, v196, v85
    v_cvt_pk_bf16_f32 v130, v84, v85
    v_mfma_f32_32x32x16_bf16 v[96:111], a[28:31], v[172:175], v[96:111]
    v_exp_f32 v87, v87
    ds_read_b64_tr_b16 a[60:61], v191 offset:4160
    ds_read_b64_tr_b16 a[62:63], v191 offset:6240
    s_waitcnt vmcnt(0)
    v_add_f32 v196, v196, v86
    s_waitcnt lgkmcnt(4)
    v_mfma_f32_32x32x16_bf16 v[16:31], a[32:35], v[136:139], v[16:31]
    v_exp_f32 v88, v88
    ds_read_b128 a[0:3], v180 offset:0
    ds_read_b128 a[4:7], v180 offset:32
    ds_write_b128 v198, a[128:131] offset:0
    v_add_f32 v196, v196, v87
    v_cvt_pk_bf16_f32 v131, v86, v87
    s_add_u32 s55, s55, 8320
    v_mfma_f32_32x32x16_bf16 v[32:47], a[36:39], v[136:139], v[32:47]
    v_exp_f32 v89, v89
    ds_read_b128 a[8:11], v181 offset:0
    ds_read_b128 a[12:15], v181 offset:32
    ds_write_b128 v198, a[132:135] offset:1040
    v_add_f32 v196, v196, v88
    s_cmp_eq_u32 s55, 74880
    s_cselect_b32 s55, 0, s55
    v_mfma_f32_32x32x16_bf16 v[48:63], a[40:43], v[136:139], v[48:63]
    v_exp_f32 v90, v90
    ds_read_b128 a[16:19], v182 offset:0
    ds_read_b128 a[20:23], v182 offset:32
    ds_write_b128 v198, a[136:139] offset:2080
    v_add_f32 v196, v196, v89
    v_cvt_pk_bf16_f32 v132, v88, v89
    v_add_u32 v188, s55, v184
    v_mfma_f32_32x32x16_bf16 v[64:79], a[44:47], v[136:139], v[64:79]
    v_exp_f32 v91, v91
    ds_read_b128 a[24:27], v183 offset:0
    ds_write_b128 v198, a[140:143] offset:3120
    v_add_f32 v196, v196, v90
    v_add_u32 v189, s55, v185
    v_max3_f32 v197, v96, v97, v98
    v_mfma_f32_32x32x16_bf16 v[16:31], a[48:51], v[140:143], v[16:31]
    v_exp_f32 v92, v92
    ds_read_b128 a[28:31], v183 offset:32
    ds_write_b128 v198, a[144:147] offset:4160
    v_add_f32 v196, v196, v91
    v_cvt_pk_bf16_f32 v133, v90, v91
    v_add_u32 v190, s55, v186
    v_max3_f32 v197, v197, v99, v100
    v_mfma_f32_32x32x16_bf16 v[32:47], a[52:55], v[140:143], v[32:47]
    v_exp_f32 v93, v93
    ds_write_b128 v198, a[148:151] offset:5200
    v_add_f32 v196, v196, v92
    v_add_u32 v191, s55, v187
    v_max3_f32 v197, v197, v101, v102
    v_max3_f32 v197, v197, v103, v104
    s_waitcnt lgkmcnt(14)
    v_mfma_f32_32x32x16_bf16 v[48:63], a[56:59], v[140:143], v[48:63]
    v_exp_f32 v94, v94
    ds_write_b128 v198, a[152:155] offset:6240
    v_add_f32 v196, v196, v93
    v_cvt_pk_bf16_f32 v134, v92, v93
    v_max3_f32 v197, v197, v105, v106
    v_max3_f32 v197, v197, v107, v108
    v_mfma_f32_32x32x16_bf16 v[64:79], a[60:63], v[140:143], v[64:79]
    v_exp_f32 v95, v95
    ds_write_b128 v198, a[156:159] offset:7280
    v_add_f32 v196, v196, v94
    v_max3_f32 v197, v197, v109, v110
    v_max_f32 v197, v197, v111
    v_add_f32 v196, v196, v95
    v_cvt_pk_bf16_f32 v135, v94, v95
    v_cmp_lt_f32 vcc, s44, v197
    s_cbranch_vccnz L_rareh1
L_rareh1_ret:
    s_branch L_ce
L_cd2:
    s_waitcnt lgkmcnt(0)
    s_barrier
    v_mfma_f32_32x32x16_bf16 v[96:111], a[0:3], v[144:147], v[112:127]
    v_exp_f32 v80, v80
    ds_read_b64_tr_b16 a[32:33], v188 offset:0
    ds_read_b64_tr_b16 a[34:35], v188 offset:2080
    v_add_u32 v198, s77, v2
    v_mfma_f32_32x32x16_bf16 v[96:111], a[4:7], v[148:151], v[96:111]
    v_exp_f32 v81, v81
    ds_read_b64_tr_b16 a[36:37], v189 offset:0
    ds_read_b64_tr_b16 a[38:39], v189 offset:2080
    v_add_u32 v180, s54, v176
    v_add_f32 v196, v196, v80
    v_mfma_f32_32x32x16_bf16 v[96:111], a[8:11], v[152:155], v[96:111]
    v_exp_f32 v82, v82
    ds_read_b64_tr_b16 a[40:41], v190 offset:0
    ds_read_b64_tr_b16 a[42:43], v190 offset:2080
    v_add_u32 v181, s54, v177
    s_add_u32 s77, s77, 24960
    v_add_f32 v196, v196, v81
    v_cvt_pk_bf16_f32 v128, v80, v81
    v_mfma_f32_32x32x16_bf16 v[96:111], a[12:15], v[156:159], v[96:111]
    v_exp_f32 v83, v83
    ds_read_b64_tr_b16 a[44:45], v191 offset:0
    ds_read_b64_tr_b16 a[46:47], v191 offset:2080
    v_add_u32 v182, s54, v178
    s_cmp_ge_u32 s77, s58
    s_cselect_b32 s46, 74880, 0
    v_add_f32 v196, v196, v82
    v_mfma_f32_32x32x16_bf16 v[96:111], a[16:19], v[160:163], v[96:111]
    v_exp_f32 v84, v84
    ds_read_b64_tr_b16 a[48:49], v188 offset:4160
    ds_read_b64_tr_b16 a[50:51], v188 offset:6240
    v_add_u32 v183, s54, v179
    s_sub_u32 s77, s77, s46
    s_mov_b32 s60, -1
    v_add_f32 v196, v196, v83
    v_cvt_pk_bf16_f32 v129, v82, v83
    v_mfma_f32_32x32x16_bf16 v[96:111], a[20:23], v[164:167], v[96:111]
    v_exp_f32 v85, v85
    ds_read_b64_tr_b16 a[52:53], v189 offset:4160
    ds_read_b64_tr_b16 a[54:55], v189 offset:6240
    s_add_u32 s54, s54, 8320
    v_add_f32 v196, v196, v84
    v_mfma_f32_32x32x16_bf16 v[96:111], a[24:27], v[168:171], v[96:111]
    v_exp_f32 v86, v86
    ds_read_b64_tr_b16 a[56:57], v190 offset:4160
    ds_read_b64_tr_b16 a[58:59], v190 offset:6240
    s_cmp_eq_u32 s54, 74880
    s_cselect_b32 s54, 0, s54
    v_add_f32 v196, v196, v85
    v_cvt_pk_bf16_f32 v130, v84, v85
    v_mfma_f32_32x32x16_bf16 v[96:111], a[28:31], v[172:175], v[96:111]
    v_exp_f32 v87, v87
    ds_read_b64_tr_b16 a[60:61], v191 offset:4160
    ds_read_b64_tr_b16 a[62:63], v191 offset:6240
    s_waitcnt vmcnt(0)
    v_add_f32 v196, v196, v86
    s_waitcnt lgkmcnt(4)
    v_mfma_f32_32x32x16_bf16 v[16:31], a[32:35], v[136:139], v[16:31]
    v_exp_f32 v88, v88
    ds_read_b128 a[0:3], v180 offset:0
    ds_read_b128 a[4:7], v180 offset:32
    ds_write_b128 v198, a[160:163] offset:0
    v_add_f32 v196, v196, v87
    v_cvt_pk_bf16_f32 v131, v86, v87
    s_add_u32 s55, s55, 8320
    v_mfma_f32_32x32x16_bf16 v[32:47], a[36:39], v[136:139], v[32:47]
    v_exp_f32 v89, v89
    ds_read_b128 a[8:11], v181 offset:0
    ds_read_b128 a[12:15], v181 offset:32
    ds_write_b128 v198, a[164:167] offset:1040
    v_add_f32 v196, v196, v88
    s_cmp_eq_u32 s55, 74880
    s_cselect_b32 s55, 0, s55
    v_mfma_f32_32x32x16_bf16 v[48:63], a[40:43], v[136:139], v[48:63]
    v_exp_f32 v90, v90
    ds_read_b128 a[16:19], v182 offset:0
    ds_read_b128 a[20:23], v182 offset:32
    ds_write_b128 v198, a[168:171] offset:2080
    v_add_f32 v196, v196, v89
    v_cvt_pk_bf16_f32 v132, v88, v89
    v_add_u32 v188, s55, v184
    v_mfma_f32_32x32x16_bf16 v[64:79], a[44:47], v[136:139], v[64:79]
    v_exp_f32 v91, v91
    ds_read_b128 a[24:27], v183 offset:0
    ds_write_b128 v198, a[172:175] offset:3120
    v_add_f32 v196, v196, v90
    v_add_u32 v189, s55, v185
    v_max3_f32 v197, v96, v97, v98
    v_mfma_f32_32x32x16_bf16 v[16:31], a[48:51], v[140:143], v[16:31]
    v_exp_f32 v92, v92
    ds_read_b128 a[28:31], v183 offset:32
    ds_write_b128 v198, a[176:179] offset:4160
    v_add_f32 v196, v196, v91
    v_cvt_pk_bf16_f32 v133, v90, v91
    v_add_u32 v190, s55, v186
    v_max3_f32 v197, v197, v99, v100
    v_mfma_f32_32x32x16_bf16 v[32:47], a[52:55], v[140:143], v[32:47]
    v_exp_f32 v93, v93
    ds_write_b128 v198, a[180:183] offset:5200
    v_add_f32 v196, v196, v92
    v_add_u32 v191, s55, v187
    v_max3_f32 v197, v197, v101, v102
    v_max3_f32 v197, v197, v103, v104
    s_waitcnt lgkmcnt(14)
    v_mfma_f32_32x32x16_bf16 v[48:63], a[56:59], v[140:143], v[48:63]
    v_exp_f32 v94, v94
    ds_write_b128 v198, a[184:187] offset:6240
    v_add_f32 v196, v196, v93
    v_cvt_pk_bf16_f32 v134, v92, v93
    v_max3_f32 v197, v197, v105, v106
    v_max3_f32 v197, v197, v107, v108
    v_mfma_f32_32x32x16_bf16 v[64:79], a[60:63], v[140:143], v[64:79]
    v_exp_f32 v95, v95
    ds_write_b128 v198, a[188:191] offset:7280
    v_add_f32 v196, v196, v94
    v_max3_f32 v197, v197, v109, v110
    v_max_f32 v197, v197, v111
    v_add_f32 v196, v196, v95
    v_cvt_pk_bf16_f32 v135, v94, v95
    v_cmp_lt_f32 vcc, s44, v197
    s_cbranch_vccnz L_rareh2
L_rareh2_ret:
    s_branch L_ce
L_tail:
    v_readfirstlane_b32 s100, v209
L_t1:
    buffer_load_dwordx4 a[96:99], v4, s[20:23], s56 offen offset:0
    buffer_load_dwordx4 a[100:103], v4, s[20:23], s56 offen offset:1024
    buffer_load_dwordx4 a[104:107], v4, s[20:23], s56 offen offset:2048
    buffer_load_dwordx4 a[108:111], v4, s[20:23], s56 offen offset:3072
    buffer_load_dwordx4 a[112:115], v5, s[20:23], s56 offen offset:0
    buffer_load_dwordx4 a[116:119], v5, s[20:23], s56 offen offset:1024
    buffer_load_dwordx4 a[120:123], v5, s[20:23], s56 offen offset:2048
    buffer_load_dwordx4 a[124:127], v5, s[20:23], s56 offen offset:3072
    s_mul_i32 s57, s56, 40
    s_add_u32 s57, s57, s62
    s_add_u32 s72, s57, 163840
    s_mul_i32 s58, s0, 40
    s_add_u32 s58, s58, s62
    s_add_u32 s73, s58, 163840
    s_mul_i32 s59, s71, 40
    s_add_u32 s59, s59, s62
    s_add_u32 s74, s59, 163840
    s_mul_i32 s60, s83, 40
    s_add_u32 s60, s60, s62
    s_add_u32 s75, s60, 163840
    s_mov_b32 s101, s100
    s_waitcnt vmcnt(8)
    s_mov_b32 s46, 25165824
    s_cmp_eq_u32 s49, 32
    s_cbranch_scc0 L_fl0
    buffer_store_dword v209, v210, s[20:23], s46 offen
    s_branch L_fl1
L_fl0:
    buffer_store_dword v209, v210, s[20:23], s46 offen sc1
L_fl1:
    s_cmp_lg_u32 s3, 0
    s_cbranch_scc1 L_idle
    s_barrier
    ds_read_b64_tr_b16 a[0:1], v220 offset:33280
    ds_read_b64_tr_b16 a[2:3], v220 offset:35360
    ds_read_b64_tr_b16 a[4:5], v221 offset:33280
    ds_read_b64_tr_b16 a[6:7], v221 offset:35360
    ds_read_b64_tr_b16 a[8:9], v222 offset:33280
    ds_read_b64_tr_b16 a[10:11], v222 offset:35360
    ds_read_b64_tr_b16 a[12:13], v223 offset:33280
    ds_read_b64_tr_b16 a[14:15], v223 offset:35360
    ds_read_b64_tr_b16 a[16:17], v220 offset:37440
    ds_read_b64_tr_b16 a[18:19], v220 offset:39520
    ds_read_b64_tr_b16 a[20:21], v221 offset:37440
    ds_read_b64_tr_b16 a[22:23], v221 offset:39520
    ds_read_b64_tr_b16 a[24:25], v222 offset:37440
    ds_read_b64_tr_b16 a[26:27], v222 offset:39520
    ds_read_b64_tr_b16 a[28:29], v223 offset:37440
    ds_read_b64_tr_b16 a[30:31], v223 offset:39520
    s_mov_b32 s45, 0xffff0000
    s_add_u32 m0, s81, 108160
    s_nop 0
    buffer_load_dwordx4 v254, s[24:27], s58 offen lds
    s_add_u32 m0, s81, 109200
    s_nop 0
    buffer_load_dwordx4 v255, s[24:27], s58 offen lds
    buffer_load_dwordx4 a[128:131], v4, s[20:23], s0 offen offset:0
    buffer_load_dwordx4 a[132:135], v4, s[20:23], s0 offen offset:1024
    s_waitcnt lgkmcnt(0)
    s_waitcnt vmcnt(12)
    v_mfma_f32_32x32x16_bf16 v[16:31], a[0:3], a[96:99], 0
    ds_read_b64_tr_b16 a[32:33], v212 offset:24960
    ds_read_b64_tr_b16 a[34:35], v212 offset:27040
    ds_read_b64_tr_b16 a[36:37], v213 offset:24960
    v_mfma_f32_32x32x16_bf16 v[32:47], a[4:7], a[96:99], 0
    buffer_load_dwordx4 a[136:139], v4, s[20:23], s0 offen offset:2048
    ds_read_b64_tr_b16 a[38:39], v213 offset:27040
    ds_read_b64_tr_b16 a[40:41], v214 offset:24960
    ds_read_b64_tr_b16 a[42:43], v214 offset:27040
    v_mfma_f32_32x32x16_bf16 v[48:63], a[8:11], a[96:99], 0
    ds_read_b64_tr_b16 a[44:45], v215 offset:24960
    ds_read_b64_tr_b16 a[46:47], v215 offset:27040
    ds_read_b64_tr_b16 a[48:49], v212 offset:29120
    v_mfma_f32_32x32x16_bf16 v[64:79], a[12:15], a[96:99], 0
    buffer_load_dwordx4 a[140:143], v4, s[20:23], s0 offen offset:3072
    ds_read_b64_tr_b16 a[50:51], v212 offset:31200
    ds_read_b64_tr_b16 a[52:53], v213 offset:29120
    ds_read_b64_tr_b16 a[54:55], v213 offset:31200
    s_waitcnt vmcnt(13)
    v_mfma_f32_32x32x16_bf16 v[16:31], a[16:19], a[100:103], v[16:31]
    ds_read_b64_tr_b16 a[56:57], v214 offset:29120
    ds_read_b64_tr_b16 a[58:59], v214 offset:31200
    v_mfma_f32_32x32x16_bf16 v[32:47], a[20:23], a[100:103], v[32:47]
    buffer_load_dwordx4 a[144:147], v5, s[20:23], s0 offen offset:0
    ds_read_b64_tr_b16 a[60:61], v215 offset:29120
    ds_read_b64_tr_b16 a[62:63], v215 offset:31200
    v_mfma_f32_32x32x16_bf16 v[48:63], a[24:27], a[100:103], v[48:63]
    v_mfma_f32_32x32x16_bf16 v[64:79], a[28:31], a[100:103], v[64:79]
    buffer_load_dwordx4 a[148:151], v5, s[20:23], s0 offen offset:1024
    s_waitcnt lgkmcnt(0)
    s_waitcnt vmcnt(14)
    v_mfma_f32_32x32x16_bf16 v[16:31], a[32:35], a[104:107], v[16:31]
    buffer_load_dwordx4 a[152:155], v5, s[20:23], s0 offen offset:2048
    ds_read_b64_tr_b16 a[0:1], v212 offset:33280
    ds_read_b64_tr_b16 a[2:3], v212 offset:35360
    ds_read_b64_tr_b16 a[4:5], v213 offset:33280
    v_mfma_f32_32x32x16_bf16 v[32:47], a[36:39], a[104:107], v[32:47]
    ds_read_b64_tr_b16 a[6:7], v213 offset:35360
    ds_read_b64_tr_b16 a[8:9], v214 offset:33280
    ds_read_b64_tr_b16 a[10:11], v214 offset:35360
    v_mfma_f32_32x32x16_bf16 v[48:63], a[40:43], a[104:107], v[48:63]
    ds_read_b64_tr_b16 a[12:13], v215 offset:33280
    ds_read_b64_tr_b16 a[14:15], v215 offset:35360
    ds_read_b64_tr_b16 a[16:17], v212 offset:37440
    v_mfma_f32_32x32x16_bf16 v[64:79], a[44:47], a[104:107], v[64:79]
    ds_read_b64_tr_b16 a[18:19], v212 offset:39520
    ds_read_b64_tr_b16 a[20:21], v213 offset:37440
    ds_read_b64_tr_b16 a[22:23], v213 offset:39520
    s_waitcnt vmcnt(14)
    v_mfma_f32_32x32x16_bf16 v[16:31], a[48:51], a[108:111], v[16:31]
    s_add_u32 m0, s81, 66560
    ds_read_b64_tr_b16 a[24:25], v214 offset:37440
    buffer_load_dwordx4 v248, s[24:27], s59 offen lds
    ds_read_b64_tr_b16 a[26:27], v214 offset:39520
    v_mfma_f32_32x32x16_bf16 v[32:47], a[52:55], a[108:111], v[32:47]
    s_add_u32 m0, s81, 67600
    ds_read_b64_tr_b16 a[28:29], v215 offset:37440
    buffer_load_dwordx4 v249, s[24:27], s59 offen lds
    ds_read_b64_tr_b16 a[30:31], v215 offset:39520
    v_mfma_f32_32x32x16_bf16 v[48:63], a[56:59], a[108:111], v[48:63]
    s_add_u32 m0, s81, 116480
    s_nop 0
    buffer_load_dwordx4 v250, s[24:27], s59 offen lds
    v_mfma_f32_32x32x16_bf16 v[64:79], a[60:63], a[108:111], v[64:79]
    s_waitcnt lgkmcnt(0)
    s_waitcnt vmcnt(16)
    v_mfma_f32_32x32x16_bf16 v[16:31], a[0:3], a[112:115], v[16:31]
    ds_read_b64_tr_b16 a[32:33], v212 offset:41600
    ds_read_b64_tr_b16 a[34:35], v212 offset:43680
    ds_read_b64_tr_b16 a[36:37], v213 offset:41600
    v_mfma_f32_32x32x16_bf16 v[32:47], a[4:7], a[112:115], v[32:47]
    ds_read_b64_tr_b16 a[38:39], v213 offset:43680
    ds_read_b64_tr_b16 a[40:41], v214 offset:41600
    ds_read_b64_tr_b16 a[42:43], v214 offset:43680
    v_mfma_f32_32x32x16_bf16 v[48:63], a[8:11], a[112:115], v[48:63]
    ds_read_b64_tr_b16 a[44:45], v215 offset:41600
    ds_read_b64_tr_b16 a[46:47], v215 offset:43680
    ds_read_b64_tr_b16 a[48:49], v212 offset:45760
    v_mfma_f32_32x32x16_bf16 v[64:79], a[12:15], a[112:115], v[64:79]
    ds_read_b64_tr_b16 a[50:51], v212 offset:47840
    ds_read_b64_tr_b16 a[52:53], v213 offset:45760
    ds_read_b64_tr_b16 a[54:55], v213 offset:47840
    s_waitcnt vmcnt(15)
    v_mfma_f32_32x32x16_bf16 v[16:31], a[16:19], a[116:119], v[16:31]
    s_add_u32 m0, s81, 117520
    ds_read_b64_tr_b16 a[56:57], v214 offset:45760
    buffer_load_dwordx4 v251, s[24:27], s59 offen lds
    ds_read_b64_tr_b16 a[58:59], v214 offset:47840
    v_mfma_f32_32x32x16_bf16 v[32:47], a[20:23], a[116:119], v[32:47]
    s_add_u32 m0, s81, 0
    ds_read_b64_tr_b16 a[60:61], v215 offset:45760
    buffer_load_dwordx4 v252, s[24:27], s59 offen lds
    ds_read_b64_tr_b16 a[62:63], v215 offset:47840
    v_mfma_f32_32x32x16_bf16 v[48:63], a[24:27], a[116:119], v[48:63]
    s_add_u32 m0, s81, 1040
    s_nop 0
    buffer_load_dwordx4 v253, s[24:27], s59 offen lds
    s_add_u32 m0, s81, 124800
    s_nop 0
    buffer_load_dwordx4 v254, s[24:27], s59 offen lds
    v_mfma_f32_32x32x16_bf16 v[64:79], a[28:31], a[116:119], v[64:79]
    s_waitcnt lgkmcnt(0)
    s_waitcnt vmcnt(14)
    s_barrier
    v_mfma_f32_32x32x16_bf16 v[16:31], a[32:35], a[120:123], v[16:31]
    ds_read_b64_tr_b16 a[0:1], v212 offset:49920
    ds_read_b64_tr_b16 a[2:3], v212 offset:52000
    ds_read_b64_tr_b16 a[4:5], v213 offset:49920
    v_mfma_f32_32x32x16_bf16 v[32:47], a[36:39], a[120:123], v[32:47]
    ds_read_b64_tr_b16 a[6:7], v213 offset:52000
    ds_read_b64_tr_b16 a[8:9], v214 offset:49920
    ds_read_b64_tr_b16 a[10:11], v214 offset:52000
    v_mfma_f32_32x32x16_bf16 v[48:63], a[40:43], a[120:123], v[48:63]
    ds_read_b64_tr_b16 a[12:13], v215 offset:49920
    ds_read_b64_tr_b16 a[14:15], v215 offset:52000
    ds_read_b64_tr_b16 a[16:17], v212 offset:54080
    v_mfma_f32_32x32x16_bf16 v[64:79], a[44:47], a[120:123], v[64:79]
    ds_read_b64_tr_b16 a[18:19], v212 offset:56160
    ds_read_b64_tr_b16 a[20:21], v213 offset:54080
    ds_read_b64_tr_b16 a[22:23], v213 offset:56160
    v_mfma_f32_32x32x16_bf16 v[16:31], a[48:51], a[124:127], v[16:31]
    s_add_u32 m0, s81, 125840
    ds_read_b64_tr_b16 a[24:25], v214 offset:54080
    buffer_load_dwordx4 v255, s[24:27], s59 offen lds
    ds_read_b64_tr_b16 a[26:27], v214 offset:56160
    v_mfma_f32_32x32x16_bf16 v[32:47], a[52:55], a[124:127], v[32:47]
    buffer_load_dwordx4 a[156:159], v5, s[20:23], s0 offen offset:3072
    buffer_load_dwordx4 a[160:163], v4, s[20:23], s71 offen offset:0
    ds_read_b64_tr_b16 a[28:29], v215 offset:54080
    ds_read_b64_tr_b16 a[30:31], v215 offset:56160
    v_mfma_f32_32x32x16_bf16 v[48:63], a[56:59], a[124:127], v[48:63]
    buffer_load_dwordx4 a[164:167], v4, s[20:23], s71 offen offset:1024
    v_mfma_f32_32x32x16_bf16 v[64:79], a[60:63], a[124:127], v[64:79]
    s_waitcnt lgkmcnt(0)
    s_waitcnt vmcnt(17)
    v_mfma_f32_32x32x16_bf16 v[16:31], a[0:3], a[128:131], v[16:31]
    buffer_load_dwordx4 a[168:171], v4, s[20:23], s71 offen offset:2048
    ds_read_b64_tr_b16 a[32:33], v216 offset:41600
    ds_read_b64_tr_b16 a[34:35], v216 offset:43680
    ds_read_b64_tr_b16 a[36:37], v217 offset:41600
    v_mfma_f32_32x32x16_bf16 v[32:47], a[4:7], a[128:131], v[32:47]
    ds_read_b64_tr_b16 a[38:39], v217 offset:43680
    ds_read_b64_tr_b16 a[40:41], v218 offset:41600
    ds_read_b64_tr_b16 a[42:43], v218 offset:43680
    v_mfma_f32_32x32x16_bf16 v[48:63], a[8:11], a[128:131], v[48:63]
    buffer_load_dwordx4 a[172:175], v4, s[20:23], s71 offen offset:3072
    ds_read_b64_tr_b16 a[44:45], v219 offset:41600
    ds_read_b64_tr_b16 a[46:47], v219 offset:43680
    ds_read_b64_tr_b16 a[48:49], v216 offset:45760
    v_mfma_f32_32x32x16_bf16 v[64:79], a[12:15], a[128:131], v[64:79]
    ds_read_b64_tr_b16 a[50:51], v216 offset:47840
    ds_read_b64_tr_b16 a[52:53], v217 offset:45760
    ds_read_b64_tr_b16 a[54:55], v217 offset:47840
    s_waitcnt vmcnt(18)
    v_mfma_f32_32x32x16_bf16 v[16:31], a[16:19], a[132:135], v[16:31]
    buffer_load_dwordx4 a[176:179], v5, s[20:23], s71 offen offset:0
    ds_read_b64_tr_b16 a[56:57], v218 offset:45760
    ds_read_b64_tr_b16 a[58:59], v218 offset:47840
    v_mfma_f32_32x32x16_bf16 v[32:47], a[20:23], a[132:135], v[32:47]
    buffer_load_dwordx4 a[180:183], v5, s[20:23], s71 offen offset:1024
    ds_read_b64_tr_b16 a[60:61], v219 offset:45760
    ds_read_b64_tr_b16 a[62:63], v219 offset:47840
    v_mfma_f32_32x32x16_bf16 v[48:63], a[24:27], a[132:135], v[48:63]
    v_mfma_f32_32x32x16_bf16 v[64:79], a[28:31], a[132:135], v[64:79]
    buffer_load_dwordx4 a[184:187], v5, s[20:23], s71 offen offset:2048
    s_waitcnt lgkmcnt(0)
    s_waitcnt vmcnt(20)
    v_mfma_f32_32x32x16_bf16 v[16:31], a[32:35], a[136:139], v[16:31]
    ds_read_b64_tr_b16 a[0:1], v216 offset:0
    ds_read_b64_tr_b16 a[2:3], v216 offset:2080
    ds_read_b64_tr_b16 a[4:5], v217 offset:0
    v_mfma_f32_32x32x16_bf16 v[32:47], a[36:39], a[136:139], v[32:47]
    ds_read_b64_tr_b16 a[6:7], v217 offset:2080
    ds_read_b64_tr_b16 a[8:9], v218 offset:0
    ds_read_b64_tr_b16 a[10:11], v218 offset:2080
    v_mfma_f32_32x32x16_bf16 v[48:63], a[40:43], a[136:139], v[48:63]
    ds_read_b64_tr_b16 a[12:13], v219 offset:0
    ds_read_b64_tr_b16 a[14:15], v219 offset:2080
    ds_read_b64_tr_b16 a[16:17], v216 offset:4160
    v_mfma_f32_32x32x16_bf16 v[64:79], a[44:47], a[136:139], v[64:79]
    ds_read_b64_tr_b16 a[18:19], v216 offset:6240
    ds_read_b64_tr_b16 a[20:21], v217 offset:4160
    ds_read_b64_tr_b16 a[22:23], v217 offset:6240
    s_waitcnt vmcnt(19)
    v_mfma_f32_32x32x16_bf16 v[16:31], a[48:51], a[140:143], v[16:31]
    s_add_u32 m0, s81, 8320
    ds_read_b64_tr_b16 a[24:25], v218 offset:4160
    buffer_load_dwordx4 v248, s[24:27], s60 offen lds
    ds_read_b64_tr_b16 a[26:27], v218 offset:6240
    v_mfma_f32_32x32x16_bf16 v[32:47], a[52:55], a[140:143], v[32:47]
    s_add_u32 m0, s81, 9360
    ds_read_b64_tr_b16 a[28:29], v219 offset:4160
    buffer_load_dwordx4 v249, s[24:27], s60 offen lds
    ds_read_b64_tr_b16 a[30:31], v219 offset:6240
    v_mfma_f32_32x32x16_bf16 v[48:63], a[56:59], a[140:143], v[48:63]
    s_add_u32 m0, s81, 133120
    s_nop 0
    buffer_load_dwordx4 v250, s[24:27], s60 offen lds
    s_add_u32 m0, s81, 134160
    s_nop 0
    buffer_load_dwordx4 v251, s[24:27], s60 offen lds
    v_mfma_f32_32x32x16_bf16 v[64:79], a[60:63], a[140:143], v[64:79]
    buffer_load_dword v208, v206, s[20:23], s70 offen sc1
    s_waitcnt lgkmcnt(0)
    s_waitcnt vmcnt(23)
    v_mfma_f32_32x32x16_bf16 v[16:31], a[0:3], a[144:147], v[16:31]
    ds_read_b64_tr_b16 a[32:33], v216 offset:49920
    ds_read_b64_tr_b16 a[34:35], v216 offset:52000
    ds_read_b64_tr_b16 a[36:37], v217 offset:49920
    v_mfma_f32_32x32x16_bf16 v[32:47], a[4:7], a[144:147], v[32:47]
    ds_read_b64_tr_b16 a[38:39], v217 offset:52000
    ds_read_b64_tr_b16 a[40:41], v218 offset:49920
    ds_read_b64_tr_b16 a[42:43], v218 offset:52000
    v_mfma_f32_32x32x16_bf16 v[48:63], a[8:11], a[144:147], v[48:63]
    ds_read_b64_tr_b16 a[44:45], v219 offset:49920
    ds_read_b64_tr_b16 a[46:47], v219 offset:52000
    ds_read_b64_tr_b16 a[48:49], v216 offset:54080
    v_mfma_f32_32x32x16_bf16 v[64:79], a[12:15], a[144:147], v[64:79]
    ds_read_b64_tr_b16 a[50:51], v216 offset:56160
    ds_read_b64_tr_b16 a[52:53], v217 offset:54080
    ds_read_b64_tr_b16 a[54:55], v217 offset:56160
    s_waitcnt vmcnt(22)
    v_mfma_f32_32x32x16_bf16 v[16:31], a[16:19], a[148:151], v[16:31]
    s_add_u32 m0, s81, 16640
    ds_read_b64_tr_b16 a[56:57], v218 offset:54080
    buffer_load_dwordx4 v252, s[24:27], s60 offen lds
    ds_read_b64_tr_b16 a[58:59], v218 offset:56160
    v_mfma_f32_32x32x16_bf16 v[32:47], a[20:23], a[148:151], v[32:47]
    s_add_u32 m0, s81, 17680
    ds_read_b64_tr_b16 a[60:61], v219 offset:54080
    buffer_load_dwordx4 v253, s[24:27], s60 offen lds
    ds_read_b64_tr_b16 a[62:63], v219 offset:56160
    v_mfma_f32_32x32x16_bf16 v[48:63], a[24:27], a[148:151], v[48:63]
    s_add_u32 m0, s81, 141440
    s_nop 0
    buffer_load_dwordx4 v254, s[24:27], s60 offen lds
    s_add_u32 m0, s81, 142480
    s_nop 0
    buffer_load_dwordx4 v255, s[24:27], s60 offen lds
    v_mfma_f32_32x32x16_bf16 v[64:79], a[28:31], a[148:151], v[64:79]
    s_waitcnt lgkmcnt(0)
    s_waitcnt vmcnt(17)
    s_barrier
    v_mfma_f32_32x32x16_bf16 v[16:31], a[32:35], a[152:155], v[16:31]
    buffer_load_dwordx4 a[188:191], v5, s[20:23], s71 offen offset:3072
    ds_read_b64_tr_b16 a[0:1], v216 offset:8320
    ds_read_b64_tr_b16 a[2:3], v216 offset:10400
    ds_read_b64_tr_b16 a[4:5], v217 offset:8320
    v_mfma_f32_32x32x16_bf16 v[32:47], a[36:39], a[152:155], v[32:47]
    ds_read_b64_tr_b16 a[6:7], v217 offset:10400
    ds_read_b64_tr_b16 a[8:9], v218 offset:8320
    ds_read_b64_tr_b16 a[10:11], v218 offset:10400
    v_mfma_f32_32x32x16_bf16 v[48:63], a[40:43], a[152:155], v[48:63]
    buffer_load_dwordx4 a[192:195], v4, s[20:23], s83 offen offset:0
    ds_read_b64_tr_b16 a[12:13], v219 offset:8320
    ds_read_b64_tr_b16 a[14:15], v219 offset:10400
    ds_read_b64_tr_b16 a[16:17], v216 offset:12480
    v_mfma_f32_32x32x16_bf16 v[64:79], a[44:47], a[152:155], v[64:79]
    ds_read_b64_tr_b16 a[18:19], v216 offset:14560
    ds_read_b64_tr_b16 a[20:21], v217 offset:12480
    ds_read_b64_tr_b16 a[22:23], v217 offset:14560
    s_waitcnt vmcnt(18)
    v_mfma_f32_32x32x16_bf16 v[16:31], a[48:51], a[156:159], v[16:31]
    buffer_load_dwordx4 a[196:199], v4, s[20:23], s83 offen offset:1024
    ds_read_b64_tr_b16 a[24:25], v218 offset:12480
    ds_read_b64_tr_b16 a[26:27], v218 offset:14560
    v_mfma_f32_32x32x16_bf16 v[32:47], a[52:55], a[156:159], v[32:47]
    ds_read_b64_tr_b16 a[28:29], v219 offset:12480
    ds_read_b64_tr_b16 a[30:31], v219 offset:14560
    v_mfma_f32_32x32x16_bf16 v[48:63], a[56:59], a[156:159], v[48:63]
    buffer_load_dwordx4 a[200:203], v4, s[20:23], s83 offen offset:2048
    v_mfma_f32_32x32x16_bf16 v[64:79], a[60:63], a[156:159], v[64:79]
    buffer_load_dwordx4 a[204:207], v4, s[20:23], s83 offen offset:3072
    s_waitcnt lgkmcnt(0)
    s_waitcnt vmcnt(9)
    v_cmp_ne_u32 vcc, v209, v208
    s_cbranch_vccnz L_blk
L_blkr:
    v_mfma_f32_32x32x16_bf16 v[16:31], a[0:3], a[160:163], v[16:31]
    ds_read_b64_tr_b16 a[32:33], v220 offset:0
    ds_read_b64_tr_b16 a[34:35], v220 offset:2080
    ds_read_b64_tr_b16 a[36:37], v221 offset:0
    v_mfma_f32_32x32x16_bf16 v[32:47], a[4:7], a[160:163], v[32:47]
    buffer_load_dwordx4 a[208:211], v5, s[20:23], s83 offen offset:0
    ds_read_b64_tr_b16 a[38:39], v221 offset:2080
    ds_read_b64_tr_b16 a[40:41], v222 offset:0
    ds_read_b64_tr_b16 a[42:43], v222 offset:2080
    v_mfma_f32_32x32x16_bf16 v[48:63], a[8:11], a[160:163], v[48:63]
    buffer_load_dwordx4 a[212:215], v5, s[20:23], s83 offen offset:1024
    ds_read_b64_tr_b16 a[44:45], v223 offset:0
    ds_read_b64_tr_b16 a[46:47], v223 offset:2080
    ds_read_b64_tr_b16 a[48:49], v220 offset:4160
    v_mfma_f32_32x32x16_bf16 v[64:79], a[12:15], a[160:163], v[64:79]
    ds_read_b64_tr_b16 a[50:51], v220 offset:6240
    ds_read_b64_tr_b16 a[52:53], v221 offset:4160
    ds_read_b64_tr_b16 a[54:55], v221 offset:6240
    v_mfma_f32_32x32x16_bf16 v[16:31], a[16:19], a[164:167], v[16:31]
    buffer_load_dwordx4 a[216:219], v5, s[20:23], s83 offen offset:2048
    ds_read_b64_tr_b16 a[56:57], v222 offset:4160
    ds_read_b64_tr_b16 a[58:59], v222 offset:6240
    v_mfma_f32_32x32x16_bf16 v[32:47], a[20:23], a[164:167], v[32:47]
    s_add_u32 m0, s81, 74880
    ds_read_b64_tr_b16 a[60:61], v223 offset:4160
    buffer_load_dwordx4 v248, s[24:27], s72 offen lds
    ds_read_b64_tr_b16 a[62:63], v223 offset:6240
    v_mfma_f32_32x32x16_bf16 v[48:63], a[24:27], a[164:167], v[48:63]
    v_mfma_f32_32x32x16_bf16 v[64:79], a[28:31], a[164:167], v[64:79]
    s_add_u32 m0, s81, 75920
    s_nop 0
    buffer_load_dwordx4 v249, s[24:27], s72 offen lds
    s_waitcnt lgkmcnt(0)
    v_mfma_f32_32x32x16_bf16 v[16:31], a[32:35], a[168:171], v[16:31]
    ds_read_b64_tr_b16 a[0:1], v212 offset:0
    ds_read_b64_tr_b16 a[2:3], v212 offset:2080
    ds_read_b64_tr_b16 a[4:5], v213 offset:0
    v_mfma_f32_32x32x16_bf16 v[32:47], a[36:39], a[168:171], v[32:47]
    ds_read_b64_tr_b16 a[6:7], v213 offset:2080
    ds_read_b64_tr_b16 a[8:9], v214 offset:0
    ds_read_b64_tr_b16 a[10:11], v214 offset:2080
    v_mfma_f32_32x32x16_bf16 v[48:63], a[40:43], a[168:171], v[48:63]
    ds_read_b64_tr_b16 a[12:13], v215 offset:0
    ds_read_b64_tr_b16 a[14:15], v215 offset:2080
    ds_read_b64_tr_b16 a[16:17], v212 offset:4160
    v_mfma_f32_32x32x16_bf16 v[64:79], a[44:47], a[168:171], v[64:79]
    ds_read_b64_tr_b16 a[18:19], v212 offset:6240
    ds_read_b64_tr_b16 a[20:21], v213 offset:4160
    ds_read_b64_tr_b16 a[22:23], v213 offset:6240
    v_mfma_f32_32x32x16_bf16 v[16:31], a[48:51], a[172:175], v[16:31]
    s_add_u32 m0, s81, 83200
    ds_read_b64_tr_b16 a[24:25], v214 offset:4160
    buffer_load_dwordx4 v250, s[24:27], s72 offen lds
    ds_read_b64_tr_b16 a[26:27], v214 offset:6240
    v_mfma_f32_32x32x16_bf16 v[32:47], a[52:55], a[172:175], v[32:47]
    s_add_u32 m0, s81, 84240
    ds_read_b64_tr_b16 a[28:29], v215 offset:4160
    buffer_load_dwordx4 v251, s[24:27], s72 offen lds
    ds_read_b64_tr_b16 a[30:31], v215 offset:6240
    v_mfma_f32_32x32x16_bf16 v[48:63], a[56:59], a[172:175], v[48:63]
    s_add_u32 m0, s81, 91520
    s_nop 0
    buffer_load_dwordx4 v252, s[24:27], s72 offen lds
    s_add_u32 m0, s81, 92560
    s_nop 0
    buffer_load_dwordx4 v253, s[24:27], s72 offen lds
    v_mfma_f32_32x32x16_bf16 v[64:79], a[60:63], a[172:175], v[64:79]
    s_waitcnt lgkmcnt(0)
    v_mfma_f32_32x32x16_bf16 v[16:31], a[0:3], a[176:179], v[16:31]
    ds_read_b64_tr_b16 a[32:33], v220 offset:8320
    ds_read_b64_tr_b16 a[34:35], v220 offset:10400
    ds_read_b64_tr_b16 a[36:37], v221 offset:8320
    v_mfma_f32_32x32x16_bf16 v[32:47], a[4:7], a[176:179], v[32:47]
    ds_read_b64_tr_b16 a[38:39], v221 offset:10400
    ds_read_b64_tr_b16 a[40:41], v222 offset:8320
    ds_read_b64_tr_b16 a[42:43], v222 offset:10400
    v_mfma_f32_32x32x16_bf16 v[48:63], a[8:11], a[176:179], v[48:63]
    ds_read_b64_tr_b16 a[44:45], v223 offset:8320
    ds_read_b64_tr_b16 a[46:47], v223 offset:10400
    ds_read_b64_tr_b16 a[48:49], v220 offset:12480
    v_mfma_f32_32x32x16_bf16 v[64:79], a[12:15], a[176:179], v[64:79]
    ds_read_b64_tr_b16 a[50:51], v220 offset:14560
    ds_read_b64_tr_b16 a[52:53], v221 offset:12480
    ds_read_b64_tr_b16 a[54:55], v221 offset:14560
    v_mfma_f32_32x32x16_bf16 v[16:31], a[16:19], a[180:183], v[16:31]
    s_add_u32 m0, s81, 149760
    ds_read_b64_tr_b16 a[56:57], v222 offset:12480
    buffer_load_dwordx4 v254, s[24:27], s72 offen lds
    ds_read_b64_tr_b16 a[58:59], v222 offset:14560
    v_mfma_f32_32x32x16_bf16 v[32:47], a[20:23], a[180:183], v[32:47]
    s_add_u32 m0, s81, 150800
    ds_read_b64_tr_b16 a[60:61], v223 offset:12480
    buffer_load_dwordx4 v255, s[24:27], s72 offen lds
    ds_read_b64_tr_b16 a[62:63], v223 offset:14560
    v_mfma_f32_32x32x16_bf16 v[48:63], a[24:27], a[180:183], v[48:63]
    s_add_u32 m0, s81, 24960
    s_nop 0
    buffer_load_dwordx4 v248, s[24:27], s73 offen lds
    s_add_u32 m0, s81, 26000
    s_nop 0
    buffer_load_dwordx4 v249, s[24:27], s73 offen lds
    v_mfma_f32_32x32x16_bf16 v[64:79], a[28:31], a[180:183], v[64:79]
    s_waitcnt lgkmcnt(0)
    s_waitcnt vmcnt(18)
    s_barrier
    v_mfma_f32_32x32x16_bf16 v[16:31], a[32:35], a[184:187], v[16:31]
    ds_read_b64_tr_b16 a[0:1], v212 offset:8320
    ds_read_b64_tr_b16 a[2:3], v212 offset:10400
    ds_read_b64_tr_b16 a[4:5], v213 offset:8320
    v_mfma_f32_32x32x16_bf16 v[32:47], a[36:39], a[184:187], v[32:47]
    ds_read_b64_tr_b16 a[6:7], v213 offset:10400
    ds_read_b64_tr_b16 a[8:9], v214 offset:8320
    ds_read_b64_tr_b16 a[10:11], v214 offset:10400
    v_mfma_f32_32x32x16_bf16 v[48:63], a[40:43], a[184:187], v[48:63]
    ds_read_b64_tr_b16 a[12:13], v215 offset:8320
    ds_read_b64_tr_b16 a[14:15], v215 offset:10400
    ds_read_b64_tr_b16 a[16:17], v212 offset:12480
    v_mfma_f32_32x32x16_bf16 v[64:79], a[44:47], a[184:187], v[64:79]
    ds_read_b64_tr_b16 a[18:19], v212 offset:14560
    ds_read_b64_tr_b16 a[20:21], v213 offset:12480
    ds_read_b64_tr_b16 a[22:23], v213 offset:14560
    s_waitcnt vmcnt(17)
    v_mfma_f32_32x32x16_bf16 v[16:31], a[48:51], a[188:191], v[16:31]
    s_add_u32 m0, s81, 33280
    ds_read_b64_tr_b16 a[24:25], v214 offset:12480
    buffer_load_dwordx4 v250, s[24:27], s73 offen lds
    ds_read_b64_tr_b16 a[26:27], v214 offset:14560
    v_mfma_f32_32x32x16_bf16 v[32:47], a[52:55], a[188:191], v[32:47]
    s_add_u32 m0, s81, 34320
    ds_read_b64_tr_b16 a[28:29], v215 offset:12480
    buffer_load_dwordx4 v251, s[24:27], s73 offen lds
    ds_read_b64_tr_b16 a[30:31], v215 offset:14560
    v_mfma_f32_32x32x16_bf16 v[48:63], a[56:59], a[188:191], v[48:63]
    s_add_u32 m0, s81, 41600
    s_nop 0
    buffer_load_dwordx4 v252, s[24:27], s73 offen lds
    s_add_u32 m0, s81, 42640
    s_nop 0
    buffer_load_dwordx4 v253, s[24:27], s73 offen lds
    v_mfma_f32_32x32x16_bf16 v[64:79], a[60:63], a[188:191], v[64:79]
    s_waitcnt lgkmcnt(0)
    s_waitcnt vmcnt(20)
    v_mfma_f32_32x32x16_bf16 v[16:31], a[0:3], a[192:195], v[16:31]
    buffer_load_dwordx4 a[220:223], v5, s[20:23], s83 offen offset:3072
    ds_read_b64_tr_b16 a[32:33], v220 offset:16640
    ds_read_b64_tr_b16 a[34:35], v220 offset:18720
    ds_read_b64_tr_b16 a[36:37], v221 offset:16640
    v_mfma_f32_32x32x16_bf16 v[32:47], a[4:7], a[192:195], v[32:47]
    buffer_load_dwordx4 v[80:83], v7, s[20:23], s56 offen offset:0
    ds_read_b64_tr_b16 a[38:39], v221 offset:18720
    ds_read_b64_tr_b16 a[40:41], v222 offset:16640
    ds_read_b64_tr_b16 a[42:43], v222 offset:18720
    v_mfma_f32_32x32x16_bf16 v[48:63], a[8:11], a[192:195], v[48:63]
    ds_read_b64_tr_b16 a[44:45], v223 offset:16640
    ds_read_b64_tr_b16 a[46:47], v223 offset:18720
    ds_read_b64_tr_b16 a[48:49], v220 offset:20800
    v_mfma_f32_32x32x16_bf16 v[64:79], a[12:15], a[192:195], v[64:79]
    buffer_load_dwordx4 v[84:87], v7, s[20:23], s56 offen offset:1024
    ds_read_b64_tr_b16 a[50:51], v220 offset:22880
    ds_read_b64_tr_b16 a[52:53], v221 offset:20800
    ds_read_b64_tr_b16 a[54:55], v221 offset:22880
    s_waitcnt vmcnt(22)
    v_mfma_f32_32x32x16_bf16 v[16:31], a[16:19], a[196:199], v[16:31]
    buffer_load_dwordx4 v[88:91], v7, s[20:23], s56 offen offset:2048
    ds_read_b64_tr_b16 a[56:57], v222 offset:20800
    ds_read_b64_tr_b16 a[58:59], v222 offset:22880
    v_mfma_f32_32x32x16_bf16 v[32:47], a[20:23], a[196:199], v[32:47]
    ds_read_b64_tr_b16 a[60:61], v223 offset:20800
    ds_read_b64_tr_b16 a[62:63], v223 offset:22880
    v_mfma_f32_32x32x16_bf16 v[48:63], a[24:27], a[196:199], v[48:63]
    buffer_load_dwordx4 v[92:95], v7, s[20:23], s56 offen offset:3072
    v_mfma_f32_32x32x16_bf16 v[64:79], a[28:31], a[196:199], v[64:79]
    buffer_load_dwordx4 v[96:99], v8, s[20:23], s56 offen offset:0
    s_waitcnt lgkmcnt(0)
    s_waitcnt vmcnt(24)
    v_mfma_f32_32x32x16_bf16 v[16:31], a[32:35], a[200:203], v[16:31]
    ds_read_b64_tr_b16 a[0:1], v212 offset:16640
    ds_read_b64_tr_b16 a[2:3], v212 offset:18720
    ds_read_b64_tr_b16 a[4:5], v213 offset:16640
    v_mfma_f32_32x32x16_bf16 v[32:47], a[36:39], a[200:203], v[32:47]
    buffer_load_dwordx4 v[100:103], v8, s[20:23], s56 offen offset:1024
    ds_read_b64_tr_b16 a[6:7], v213 offset:18720
    ds_read_b64_tr_b16 a[8:9], v214 offset:16640
    ds_read_b64_tr_b16 a[10:11], v214 offset:18720
    v_mfma_f32_32x32x16_bf16 v[48:63], a[40:43], a[200:203], v[48:63]
    buffer_load_dwordx4 v[104:107], v8, s[20:23], s56 offen offset:2048
    ds_read_b64_tr_b16 a[12:13], v215 offset:16640
    ds_read_b64_tr_b16 a[14:15], v215 offset:18720
    ds_read_b64_tr_b16 a[16:17], v212 offset:20800
    v_mfma_f32_32x32x16_bf16 v[64:79], a[44:47], a[200:203], v[64:79]
    ds_read_b64_tr_b16 a[18:19], v212 offset:22880
    ds_read_b64_tr_b16 a[20:21], v213 offset:20800
    ds_read_b64_tr_b16 a[22:23], v213 offset:22880
    s_waitcnt vmcnt(25)
    v_mfma_f32_32x32x16_bf16 v[16:31], a[48:51], a[204:207], v[16:31]
    buffer_load_dwordx4 v[108:111], v8, s[20:23], s56 offen offset:3072
    ds_read_b64_tr_b16 a[24:25], v214 offset:20800
    ds_read_b64_tr_b16 a[26:27], v214 offset:22880
    v_mfma_f32_32x32x16_bf16 v[32:47], a[52:55], a[204:207], v[32:47]
    buffer_load_dwordx4 v[112:115], v7, s[20:23], s0 offen offset:0
    ds_read_b64_tr_b16 a[28:29], v215 offset:20800
    ds_read_b64_tr_b16 a[30:31], v215 offset:22880
    v_mfma_f32_32x32x16_bf16 v[48:63], a[56:59], a[204:207], v[48:63]
    v_mfma_f32_32x32x16_bf16 v[64:79], a[60:63], a[204:207], v[64:79]
    buffer_load_dwordx4 v[116:119], v7, s[20:23], s0 offen offset:1024
    s_waitcnt lgkmcnt(0)
    s_waitcnt vmcnt(27)
    v_mfma_f32_32x32x16_bf16 v[16:31], a[0:3], a[208:211], v[16:31]
    buffer_load_dwordx4 v[120:123], v7, s[20:23], s0 offen offset:2048
    ds_read_b64_tr_b16 a[32:33], v220 offset:24960
    ds_read_b64_tr_b16 a[34:35], v220 offset:27040
    ds_read_b64_tr_b16 a[36:37], v221 offset:24960
    v_mfma_f32_32x32x16_bf16 v[32:47], a[4:7], a[208:211], v[32:47]
    ds_read_b64_tr_b16 a[38:39], v221 offset:27040
    ds_read_b64_tr_b16 a[40:41], v222 offset:24960
    ds_read_b64_tr_b16 a[42:43], v222 offset:27040
    v_mfma_f32_32x32x16_bf16 v[48:63], a[8:11], a[208:211], v[48:63]
    buffer_load_dwordx4 v[124:127], v7, s[20:23], s0 offen offset:3072
    ds_read_b64_tr_b16 a[44:45], v223 offset:24960
    ds_read_b64_tr_b16 a[46:47], v223 offset:27040
    ds_read_b64_tr_b16 a[48:49], v220 offset:29120
    v_mfma_f32_32x32x16_bf16 v[64:79], a[12:15], a[208:211], v[64:79]
    buffer_load_dwordx4 v[128:131], v8, s[20:23], s0 offen offset:0
    ds_read_b64_tr_b16 a[50:51], v220 offset:31200
    ds_read_b64_tr_b16 a[52:53], v221 offset:29120
    ds_read_b64_tr_b16 a[54:55], v221 offset:31200
    s_waitcnt vmcnt(29)
    v_mfma_f32_32x32x16_bf16 v[16:31], a[16:19], a[212:215], v[16:31]
    ds_read_b64_tr_b16 a[56:57], v222 offset:29120
    ds_read_b64_tr_b16 a[58:59], v222 offset:31200
    v_mfma_f32_32x32x16_bf16 v[32:47], a[20:23], a[212:215], v[32:47]
    s_add_u32 m0, s81, 49920
    ds_read_b64_tr_b16 a[60:61], v223 offset:29120
    buffer_load_dwordx4 v254, s[24:27], s73 offen lds
    ds_read_b64_tr_b16 a[62:63], v223 offset:31200
    v_mfma_f32_32x32x16_bf16 v[48:63], a[24:27], a[212:215], v[48:63]
    s_add_u32 m0, s81, 50960
    s_nop 0
    buffer_load_dwordx4 v255, s[24:27], s73 offen lds
    v_mfma_f32_32x32x16_bf16 v[64:79], a[28:31], a[212:215], v[64:79]
    s_waitcnt lgkmcnt(0)
    s_waitcnt vmcnt(16)
    s_barrier
    v_mfma_f32_32x32x16_bf16 v[16:31], a[32:35], a[216:219], v[16:31]
    ds_read_b64_tr_b16 a[0:1], v216 offset:16640
    ds_read_b64_tr_b16 a[2:3], v216 offset:18720
    ds_read_b64_tr_b16 a[4:5], v217 offset:16640
    v_mfma_f32_32x32x16_bf16 v[32:47], a[36:39], a[216:219], v[32:47]
    ds_read_b64_tr_b16 a[6:7], v217 offset:18720
    ds_read_b64_tr_b16 a[8:9], v218 offset:16640
    ds_read_b64_tr_b16 a[10:11], v218 offset:18720
    v_mfma_f32_32x32x16_bf16 v[48:63], a[40:43], a[216:219], v[48:63]
    ds_read_b64_tr_b16 a[16:17], v216 offset:20800
    ds_read_b64_tr_b16 a[18:19], v216 offset:22880
    ds_read_b64_tr_b16 a[20:21], v217 offset:20800
    v_mfma_f32_32x32x16_bf16 v[64:79], a[44:47], a[216:219], v[64:79]
    ds_read_b64_tr_b16 a[22:23], v217 offset:22880
    ds_read_b64_tr_b16 a[24:25], v218 offset:20800
    ds_read_b64_tr_b16 a[26:27], v218 offset:22880
    s_waitcnt vmcnt(15)
    v_mfma_f32_32x32x16_bf16 v[16:31], a[48:51], a[220:223], v[16:31]
    s_add_u32 m0, s81, 99840
    ds_read_b64_tr_b16 a[96:97], v219 offset:16640
    buffer_load_dwordx4 v248, s[24:27], s74 offen lds
    ds_read_b64_tr_b16 a[98:99], v219 offset:18720
    v_mfma_f32_32x32x16_bf16 v[32:47], a[52:55], a[220:223], v[32:47]
    s_add_u32 m0, s81, 100880
    ds_read_b64_tr_b16 a[100:101], v219 offset:20800
    buffer_load_dwordx4 v249, s[24:27], s74 offen lds
    ds_read_b64_tr_b16 a[102:103], v219 offset:22880
    v_mfma_f32_32x32x16_bf16 v[48:63], a[56:59], a[220:223], v[48:63]
    s_add_u32 m0, s81, 58240
    s_nop 0
    buffer_load_dwordx4 v250, s[24:27], s74 offen lds
    s_add_u32 m0, s81, 59280
    s_nop 0
    buffer_load_dwordx4 v251, s[24:27], s74 offen lds
    v_mfma_f32_32x32x16_bf16 v[64:79], a[60:63], a[220:223], v[64:79]
    s_waitcnt lgkmcnt(0)
    s_waitcnt vmcnt(18)
    v_mfma_f32_32x32x16_bf16 v[16:31], a[0:3], v[80:83], v[16:31]
    ds_read_b64_tr_b16 a[32:33], v216 offset:24960
    ds_read_b64_tr_b16 a[34:35], v216 offset:27040
    ds_read_b64_tr_b16 a[36:37], v217 offset:24960
    v_mfma_f32_32x32x16_bf16 v[32:47], a[4:7], v[80:83], v[32:47]
    ds_read_b64_tr_b16 a[38:39], v217 offset:27040
    ds_read_b64_tr_b16 a[40:41], v218 offset:24960
    ds_read_b64_tr_b16 a[42:43], v218 offset:27040
    v_mfma_f32_32x32x16_bf16 v[48:63], a[8:11], v[80:83], v[48:63]
    ds_read_b64_tr_b16 a[48:49], v216 offset:29120
    ds_read_b64_tr_b16 a[50:51], v216 offset:31200
    ds_read_b64_tr_b16 a[52:53], v217 offset:29120
    s_waitcnt vmcnt(17)
    v_mfma_f32_32x32x16_bf16 v[16:31], a[16:19], v[84:87], v[16:31]
    ds_read_b64_tr_b16 a[54:55], v217 offset:31200
    ds_read_b64_tr_b16 a[56:57], v218 offset:29120
    ds_read_b64_tr_b16 a[58:59], v218 offset:31200
    v_mfma_f32_32x32x16_bf16 v[32:47], a[20:23], v[84:87], v[32:47]
    ds_read_b64_tr_b16 a[104:105], v219 offset:24960
    ds_read_b64_tr_b16 a[106:107], v219 offset:27040
    ds_read_b64_tr_b16 a[108:109], v219 offset:29120
    v_mfma_f32_32x32x16_bf16 v[48:63], a[24:27], v[84:87], v[48:63]
    s_add_u32 m0, s81, 108160
    ds_read_b64_tr_b16 a[110:111], v219 offset:31200
    buffer_load_dwordx4 v252, s[24:27], s74 offen lds
    s_waitcnt lgkmcnt(4)
    s_waitcnt vmcnt(17)
    v_mfma_f32_32x32x16_bf16 v[16:31], a[32:35], v[88:91], v[16:31]
    ds_read_b64_tr_b16 a[0:1], v216 offset:33280
    ds_read_b64_tr_b16 a[2:3], v216 offset:35360
    ds_read_b64_tr_b16 a[4:5], v217 offset:33280
    v_mfma_f32_32x32x16_bf16 v[32:47], a[36:39], v[88:91], v[32:47]
    ds_read_b64_tr_b16 a[6:7], v217 offset:35360
    ds_read_b64_tr_b16 a[8:9], v218 offset:33280
    ds_read_b64_tr_b16 a[10:11], v218 offset:35360
    v_mfma_f32_32x32x16_bf16 v[48:63], a[40:43], v[88:91], v[48:63]
    ds_read_b64_tr_b16 a[16:17], v216 offset:37440
    ds_read_b64_tr_b16 a[18:19], v216 offset:39520
    ds_read_b64_tr_b16 a[20:21], v217 offset:37440
    s_waitcnt vmcnt(16)
    v_mfma_f32_32x32x16_bf16 v[16:31], a[48:51], v[92:95], v[16:31]
    ds_read_b64_tr_b16 a[22:23], v217 offset:39520
    ds_read_b64_tr_b16 a[24:25], v218 offset:37440
    ds_read_b64_tr_b16 a[26:27], v218 offset:39520
    v_mfma_f32_32x32x16_bf16 v[32:47], a[52:55], v[92:95], v[32:47]
    ds_read_b64_tr_b16 a[112:113], v219 offset:33280
    ds_read_b64_tr_b16 a[114:115], v219 offset:35360
    ds_read_b64_tr_b16 a[116:117], v219 offset:37440
    v_mfma_f32_32x32x16_bf16 v[48:63], a[56:59], v[92:95], v[48:63]
    s_add_u32 m0, s81, 109200
    ds_read_b64_tr_b16 a[118:119], v219 offset:39520
    buffer_load_dwordx4 v253, s[24:27], s74 offen lds
    s_waitcnt lgkmcnt(4)
    s_waitcnt vmcnt(16)
    v_mfma_f32_32x32x16_bf16 v[16:31], a[0:3], v[96:99], v[16:31]
    ds_read_b64_tr_b16 a[32:33], v220 offset:33280
    ds_read_b64_tr_b16 a[34:35], v220 offset:35360
    ds_read_b64_tr_b16 a[36:37], v221 offset:33280
    v_mfma_f32_32x32x16_bf16 v[32:47], a[4:7], v[96:99], v[32:47]
    s_add_u32 m0, s81, 66560
    ds_read_b64_tr_b16 a[38:39], v221 offset:35360
    buffer_load_dwordx4 v254, s[24:27], s74 offen lds
    ds_read_b64_tr_b16 a[40:41], v222 offset:33280
    ds_read_b64_tr_b16 a[42:43], v222 offset:35360
    v_mfma_f32_32x32x16_bf16 v[48:63], a[8:11], v[96:99], v[48:63]
    s_add_u32 m0, s81, 67600
    ds_read_b64_tr_b16 a[48:49], v220 offset:37440
    buffer_load_dwordx4 v255, s[24:27], s74 offen lds
    ds_read_b64_tr_b16 a[50:51], v220 offset:39520
    ds_read_b64_tr_b16 a[52:53], v221 offset:37440
    s_waitcnt vmcnt(17)
    v_mfma_f32_32x32x16_bf16 v[16:31], a[16:19], v[100:103], v[16:31]
    s_add_u32 m0, s81, 116480
    ds_read_b64_tr_b16 a[54:55], v221 offset:39520
    buffer_load_dwordx4 v248, s[24:27], s75 offen lds
    ds_read_b64_tr_b16 a[56:57], v222 offset:37440
    ds_read_b64_tr_b16 a[58:59], v222 offset:39520
    v_mfma_f32_32x32x16_bf16 v[32:47], a[20:23], v[100:103], v[32:47]
    s_add_u32 m0, s81, 117520
    ds_read_b64_tr_b16 a[120:121], v223 offset:33280
    buffer_load_dwordx4 v249, s[24:27], s75 offen lds
    ds_read_b64_tr_b16 a[122:123], v223 offset:35360
    ds_read_b64_tr_b16 a[124:125], v223 offset:37440
    v_mfma_f32_32x32x16_bf16 v[48:63], a[24:27], v[100:103], v[48:63]
    s_add_u32 m0, s81, 0
    ds_read_b64_tr_b16 a[126:127], v223 offset:39520
    buffer_load_dwordx4 v250, s[24:27], s75 offen lds
    s_add_u32 m0, s81, 1040
    s_nop 0
    buffer_load_dwordx4 v251, s[24:27], s75 offen lds
    s_waitcnt lgkmcnt(4)
    s_waitcnt vmcnt(20)
    v_mfma_f32_32x32x16_bf16 v[16:31], a[32:35], v[104:107], v[16:31]
    s_add_u32 m0, s81, 124800
    ds_read_b64_tr_b16 a[0:1], v212 offset:24960
    buffer_load_dwordx4 v252, s[24:27], s75 offen lds
    ds_read_b64_tr_b16 a[2:3], v212 offset:27040
    ds_read_b64_tr_b16 a[4:5], v213 offset:24960
    v_mfma_f32_32x32x16_bf16 v[32:47], a[36:39], v[104:107], v[32:47]
    s_add_u32 m0, s81, 125840
    ds_read_b64_tr_b16 a[6:7], v213 offset:27040
    buffer_load_dwordx4 v253, s[24:27], s75 offen lds
    ds_read_b64_tr_b16 a[8:9], v214 offset:24960
    ds_read_b64_tr_b16 a[10:11], v214 offset:27040
    v_mfma_f32_32x32x16_bf16 v[48:63], a[40:43], v[104:107], v[48:63]
    s_add_u32 m0, s81, 8320
    ds_read_b64_tr_b16 a[16:17], v212 offset:29120
    buffer_load_dwordx4 v254, s[24:27], s75 offen lds
    ds_read_b64_tr_b16 a[18:19], v212 offset:31200
    ds_read_b64_tr_b16 a[20:21], v213 offset:29120
    s_waitcnt vmcnt(22)
    v_mfma_f32_32x32x16_bf16 v[16:31], a[48:51], v[108:111], v[16:31]
    s_add_u32 m0, s81, 9360
    ds_read_b64_tr_b16 a[22:23], v213 offset:31200
    buffer_load_dwordx4 v255, s[24:27], s75 offen lds
    buffer_load_dwordx4 v[132:135], v8, s[20:23], s0 offen offset:1024
    ds_read_b64_tr_b16 a[24:25], v214 offset:29120
    ds_read_b64_tr_b16 a[26:27], v214 offset:31200
    v_mfma_f32_32x32x16_bf16 v[32:47], a[52:55], v[108:111], v[32:47]
    buffer_load_dwordx4 v[136:139], v8, s[20:23], s0 offen offset:2048
    buffer_load_dwordx4 v[140:143], v8, s[20:23], s0 offen offset:3072
    ds_read_b64_tr_b16 a[128:129], v215 offset:24960
    ds_read_b64_tr_b16 a[130:131], v215 offset:27040
    ds_read_b64_tr_b16 a[132:133], v215 offset:29120
    v_mfma_f32_32x32x16_bf16 v[48:63], a[56:59], v[108:111], v[48:63]
    ds_read_b64_tr_b16 a[134:135], v215 offset:31200
    s_waitcnt lgkmcnt(4)
    s_waitcnt vmcnt(25)
    v_mfma_f32_32x32x16_bf16 v[16:31], a[0:3], v[112:115], v[16:31]
    ds_read_b64_tr_b16 a[32:33], v212 offset:33280
    ds_read_b64_tr_b16 a[34:35], v212 offset:35360
    ds_read_b64_tr_b16 a[36:37], v213 offset:33280
    v_mfma_f32_32x32x16_bf16 v[32:47], a[4:7], v[112:115], v[32:47]
    buffer_load_dwordx4 a[64:67], v7, s[20:23], s71 offen offset:0
    ds_read_b64_tr_b16 a[38:39], v213 offset:35360
    ds_read_b64_tr_b16 a[40:41], v214 offset:33280
    ds_read_b64_tr_b16 a[42:43], v214 offset:35360
    v_mfma_f32_32x32x16_bf16 v[48:63], a[8:11], v[112:115], v[48:63]
    ds_read_b64_tr_b16 a[48:49], v212 offset:37440
    ds_read_b64_tr_b16 a[50:51], v212 offset:39520
    ds_read_b64_tr_b16 a[52:53], v213 offset:37440
    s_waitcnt vmcnt(25)
    v_mfma_f32_32x32x16_bf16 v[16:31], a[16:19], v[116:119], v[16:31]
    ds_read_b64_tr_b16 a[54:55], v213 offset:39520
    ds_read_b64_tr_b16 a[56:57], v214 offset:37440
    ds_read_b64_tr_b16 a[58:59], v214 offset:39520
    v_mfma_f32_32x32x16_bf16 v[32:47], a[20:23], v[116:119], v[32:47]
    buffer_load_dwordx4 a[68:71], v7, s[20:23], s71 offen offset:1024
    ds_read_b64_tr_b16 a[136:137], v215 offset:33280
    ds_read_b64_tr_b16 a[138:139], v215 offset:35360
    ds_read_b64_tr_b16 a[140:141], v215 offset:37440
    v_mfma_f32_32x32x16_bf16 v[48:63], a[24:27], v[116:119], v[48:63]
    ds_read_b64_tr_b16 a[142:143], v215 offset:39520
    s_waitcnt lgkmcnt(4)
    s_waitcnt vmcnt(25)
    v_mfma_f32_32x32x16_bf16 v[16:31], a[32:35], v[120:123], v[16:31]
    ds_read_b64_tr_b16 a[0:1], v212 offset:41600
    ds_read_b64_tr_b16 a[2:3], v212 offset:43680
    ds_read_b64_tr_b16 a[4:5], v213 offset:41600
    v_mfma_f32_32x32x16_bf16 v[32:47], a[36:39], v[120:123], v[32:47]
    buffer_load_dwordx4 a[72:75], v7, s[20:23], s71 offen offset:2048
    ds_read_b64_tr_b16 a[6:7], v213 offset:43680
    ds_read_b64_tr_b16 a[8:9], v214 offset:41600
    ds_read_b64_tr_b16 a[10:11], v214 offset:43680
    v_mfma_f32_32x32x16_bf16 v[48:63], a[40:43], v[120:123], v[48:63]
    ds_read_b64_tr_b16 a[16:17], v212 offset:45760
    ds_read_b64_tr_b16 a[18:19], v212 offset:47840
    ds_read_b64_tr_b16 a[20:21], v213 offset:45760
    s_waitcnt vmcnt(25)
    v_mfma_f32_32x32x16_bf16 v[16:31], a[48:51], v[124:127], v[16:31]
    ds_read_b64_tr_b16 a[22:23], v213 offset:47840
    ds_read_b64_tr_b16 a[24:25], v214 offset:45760
    ds_read_b64_tr_b16 a[26:27], v214 offset:47840
    v_mfma_f32_32x32x16_bf16 v[32:47], a[52:55], v[124:127], v[32:47]
    buffer_load_dwordx4 a[76:79], v7, s[20:23], s71 offen offset:3072
    ds_read_b64_tr_b16 a[144:145], v215 offset:41600
    ds_read_b64_tr_b16 a[146:147], v215 offset:43680
    ds_read_b64_tr_b16 a[148:149], v215 offset:45760
    v_mfma_f32_32x32x16_bf16 v[48:63], a[56:59], v[124:127], v[48:63]
    ds_read_b64_tr_b16 a[150:151], v215 offset:47840
    s_waitcnt lgkmcnt(0)
    s_waitcnt vmcnt(7)
    s_barrier
    v_mfma_f32_32x32x16_bf16 v[16:31], a[0:3], v[128:131], v[16:31]
    buffer_load_dwordx4 a[80:83], v8, s[20:23], s71 offen offset:0
    ds_read_b64_tr_b16 a[32:33], v212 offset:49920
    ds_read_b64_tr_b16 a[34:35], v212 offset:52000
    ds_read_b64_tr_b16 a[36:37], v213 offset:49920
    v_mfma_f32_32x32x16_bf16 v[32:47], a[4:7], v[128:131], v[32:47]
    ds_read_b64_tr_b16 a[38:39], v213 offset:52000
    ds_read_b64_tr_b16 a[40:41], v214 offset:49920
    ds_read_b64_tr_b16 a[42:43], v214 offset:52000
    v_mfma_f32_32x32x16_bf16 v[48:63], a[8:11], v[128:131], v[48:63]
    buffer_load_dwordx4 a[84:87], v8, s[20:23], s71 offen offset:1024
    ds_read_b64_tr_b16 a[48:49], v212 offset:54080
    ds_read_b64_tr_b16 a[50:51], v212 offset:56160
    ds_read_b64_tr_b16 a[52:53], v213 offset:54080
    s_waitcnt vmcnt(8)
    v_mfma_f32_32x32x16_bf16 v[16:31], a[16:19], v[132:135], v[16:31]
    buffer_load_dwordx4 a[88:91], v8, s[20:23], s71 offen offset:2048
    ds_read_b64_tr_b16 a[54:55], v213 offset:56160
    ds_read_b64_tr_b16 a[56:57], v214 offset:54080
    ds_read_b64_tr_b16 a[58:59], v214 offset:56160
    v_mfma_f32_32x32x16_bf16 v[32:47], a[20:23], v[132:135], v[32:47]
    ds_read_b64_tr_b16 a[152:153], v215 offset:49920
    ds_read_b64_tr_b16 a[154:155], v215 offset:52000
    ds_read_b64_tr_b16 a[156:157], v215 offset:54080
    v_mfma_f32_32x32x16_bf16 v[48:63], a[24:27], v[132:135], v[48:63]
    buffer_load_dwordx4 a[92:95], v8, s[20:23], s71 offen offset:3072
    ds_read_b64_tr_b16 a[158:159], v215 offset:56160
    s_waitcnt lgkmcnt(4)
    s_waitcnt vmcnt(9)
    v_mfma_f32_32x32x16_bf16 v[16:31], a[32:35], v[136:139], v[16:31]
    buffer_load_dwordx4 a[224:227], v7, s[20:23], s83 offen offset:0
    ds_read_b64_tr_b16 a[0:1], v216 offset:41600
    ds_read_b64_tr_b16 a[2:3], v216 offset:43680
    ds_read_b64_tr_b16 a[4:5], v217 offset:41600
    v_mfma_f32_32x32x16_bf16 v[32:47], a[36:39], v[136:139], v[32:47]
    ds_read_b64_tr_b16 a[6:7], v217 offset:43680
    ds_read_b64_tr_b16 a[8:9], v218 offset:41600
    ds_read_b64_tr_b16 a[10:11], v218 offset:43680
    v_mfma_f32_32x32x16_bf16 v[48:63], a[40:43], v[136:139], v[48:63]
    buffer_load_dwordx4 a[228:231], v7, s[20:23], s83 offen offset:1024
    ds_read_b64_tr_b16 a[16:17], v216 offset:45760
    ds_read_b64_tr_b16 a[18:19], v216 offset:47840
    ds_read_b64_tr_b16 a[20:21], v217 offset:45760
    s_waitcnt vmcnt(10)
    v_mfma_f32_32x32x16_bf16 v[16:31], a[48:51], v[140:143], v[16:31]
    buffer_load_dwordx4 a[232:235], v7, s[20:23], s83 offen offset:2048
    ds_read_b64_tr_b16 a[22:23], v217 offset:47840
    ds_read_b64_tr_b16 a[24:25], v218 offset:45760
    ds_read_b64_tr_b16 a[26:27], v218 offset:47840
    v_mfma_f32_32x32x16_bf16 v[32:47], a[52:55], v[140:143], v[32:47]
    ds_read_b64_tr_b16 a[160:161], v219 offset:41600
    ds_read_b64_tr_b16 a[162:163], v219 offset:43680
    ds_read_b64_tr_b16 a[164:165], v219 offset:45760
    v_mfma_f32_32x32x16_bf16 v[48:63], a[56:59], v[140:143], v[48:63]
    buffer_load_dwordx4 a[236:239], v7, s[20:23], s83 offen offset:3072
    ds_read_b64_tr_b16 a[166:167], v219 offset:47840
    s_waitcnt lgkmcnt(4)
    s_waitcnt vmcnt(11)
    v_mfma_f32_32x32x16_bf16 v[16:31], a[0:3], a[64:67], v[16:31]
    buffer_load_dwordx4 a[240:243], v8, s[20:23], s83 offen offset:0
    ds_read_b64_tr_b16 a[32:33], v216 offset:0
    ds_read_b64_tr_b16 a[34:35], v216 offset:2080
    ds_read_b64_tr_b16 a[36:37], v217 offset:0
    v_mfma_f32_32x32x16_bf16 v[32:47], a[4:7], a[64:67], v[32:47]
    ds_read_b64_tr_b16 a[38:39], v217 offset:2080
    ds_read_b64_tr_b16 a[40:41], v218 offset:0
    ds_read_b64_tr_b16 a[42:43], v218 offset:2080
    v_mfma_f32_32x32x16_bf16 v[48:63], a[8:11], a[64:67], v[48:63]
    buffer_load_dwordx4 a[244:247], v8, s[20:23], s83 offen offset:1024
    ds_read_b64_tr_b16 a[48:49], v216 offset:4160
    ds_read_b64_tr_b16 a[50:51], v216 offset:6240
    ds_read_b64_tr_b16 a[52:53], v217 offset:4160
    s_waitcnt vmcnt(12)
    v_mfma_f32_32x32x16_bf16 v[16:31], a[16:19], a[68:71], v[16:31]
    buffer_load_dwordx4 a[248:251], v8, s[20:23], s83 offen offset:2048
    ds_read_b64_tr_b16 a[54:55], v217 offset:6240
    ds_read_b64_tr_b16 a[56:57], v218 offset:4160
    ds_read_b64_tr_b16 a[58:59], v218 offset:6240
    v_mfma_f32_32x32x16_bf16 v[32:47], a[20:23], a[68:71], v[32:47]
    ds_read_b64_tr_b16 a[168:169], v219 offset:0
    ds_read_b64_tr_b16 a[170:171], v219 offset:2080
    ds_read_b64_tr_b16 a[172:173], v219 offset:4160
    v_mfma_f32_32x32x16_bf16 v[48:63], a[24:27], a[68:71], v[48:63]
    buffer_load_dwordx4 a[252:255], v8, s[20:23], s83 offen offset:3072
    ds_read_b64_tr_b16 a[174:175], v219 offset:6240
    s_waitcnt lgkmcnt(4)
    s_waitcnt vmcnt(13)
    v_mfma_f32_32x32x16_bf16 v[16:31], a[32:35], a[72:75], v[16:31]
    ds_read_b64_tr_b16 a[0:1], v216 offset:49920
    ds_read_b64_tr_b16 a[2:3], v216 offset:52000
    ds_read_b64_tr_b16 a[4:5], v217 offset:49920
    v_mfma_f32_32x32x16_bf16 v[32:47], a[36:39], a[72:75], v[32:47]
    ds_read_b64_tr_b16 a[6:7], v217 offset:52000
    ds_read_b64_tr_b16 a[8:9], v218 offset:49920
    ds_read_b64_tr_b16 a[10:11], v218 offset:52000
    v_mfma_f32_32x32x16_bf16 v[48:63], a[40:43], a[72:75], v[48:63]
    ds_read_b64_tr_b16 a[16:17], v216 offset:54080
    ds_read_b64_tr_b16 a[18:19], v216 offset:56160
    ds_read_b64_tr_b16 a[20:21], v217 offset:54080
    s_waitcnt vmcnt(12)
    v_mfma_f32_32x32x16_bf16 v[16:31], a[48:51], a[76:79], v[16:31]
    ds_read_b64_tr_b16 a[22:23], v217 offset:56160
    ds_read_b64_tr_b16 a[24:25], v218 offset:54080
    ds_read_b64_tr_b16 a[26:27], v218 offset:56160
    v_mfma_f32_32x32x16_bf16 v[32:47], a[52:55], a[76:79], v[32:47]
    ds_read_b64_tr_b16 a[176:177], v219 offset:49920
    ds_read_b64_tr_b16 a[178:179], v219 offset:52000
    ds_read_b64_tr_b16 a[180:181], v219 offset:54080
    v_mfma_f32_32x32x16_bf16 v[48:63], a[56:59], a[76:79], v[48:63]
    ds_read_b64_tr_b16 a[182:183], v219 offset:56160
    s_waitcnt lgkmcnt(4)
    s_waitcnt vmcnt(11)
    v_mfma_f32_32x32x16_bf16 v[16:31], a[0:3], a[80:83], v[16:31]
    ds_read_b64_tr_b16 a[32:33], v216 offset:8320
    ds_read_b64_tr_b16 a[34:35], v216 offset:10400
    ds_read_b64_tr_b16 a[36:37], v217 offset:8320
    v_mfma_f32_32x32x16_bf16 v[32:47], a[4:7], a[80:83], v[32:47]
    ds_read_b64_tr_b16 a[38:39], v217 offset:10400
    ds_read_b64_tr_b16 a[40:41], v218 offset:8320
    ds_read_b64_tr_b16 a[42:43], v218 offset:10400
    v_mfma_f32_32x32x16_bf16 v[48:63], a[8:11], a[80:83], v[48:63]
    ds_read_b64_tr_b16 a[48:49], v216 offset:12480
    ds_read_b64_tr_b16 a[50:51], v216 offset:14560
    ds_read_b64_tr_b16 a[52:53], v217 offset:12480
    s_waitcnt vmcnt(10)
    v_mfma_f32_32x32x16_bf16 v[16:31], a[16:19], a[84:87], v[16:31]
    ds_read_b64_tr_b16 a[54:55], v217 offset:14560
    ds_read_b64_tr_b16 a[56:57], v218 offset:12480
    ds_read_b64_tr_b16 a[58:59], v218 offset:14560
    v_mfma_f32_32x32x16_bf16 v[32:47], a[20:23], a[84:87], v[32:47]
    ds_read_b64_tr_b16 a[184:185], v219 offset:8320
    ds_read_b64_tr_b16 a[186:187], v219 offset:10400
    ds_read_b64_tr_b16 a[188:189], v219 offset:12480
    v_mfma_f32_32x32x16_bf16 v[48:63], a[24:27], a[84:87], v[48:63]
    ds_read_b64_tr_b16 a[190:191], v219 offset:14560
    s_waitcnt lgkmcnt(4)
    s_waitcnt vmcnt(9)
    v_mfma_f32_32x32x16_bf16 v[16:31], a[32:35], a[88:91], v[16:31]
    ds_read_b64_tr_b16 a[0:1], v220 offset:0
    ds_read_b64_tr_b16 a[2:3], v220 offset:2080
    ds_read_b64_tr_b16 a[4:5], v221 offset:0
    v_mfma_f32_32x32x16_bf16 v[32:47], a[36:39], a[88:91], v[32:47]
    ds_read_b64_tr_b16 a[6:7], v221 offset:2080
    ds_read_b64_tr_b16 a[8:9], v222 offset:0
    ds_read_b64_tr_b16 a[10:11], v222 offset:2080
    v_mfma_f32_32x32x16_bf16 v[48:63], a[40:43], a[88:91], v[48:63]
    ds_read_b64_tr_b16 a[16:17], v220 offset:4160
    ds_read_b64_tr_b16 a[18:19], v220 offset:6240
    ds_read_b64_tr_b16 a[20:21], v221 offset:4160
    s_waitcnt vmcnt(8)
    v_mfma_f32_32x32x16_bf16 v[16:31], a[48:51], a[92:95], v[16:31]
    ds_read_b64_tr_b16 a[22:23], v221 offset:6240
    ds_read_b64_tr_b16 a[24:25], v222 offset:4160
    ds_read_b64_tr_b16 a[26:27], v222 offset:6240
    v_mfma_f32_32x32x16_bf16 v[32:47], a[52:55], a[92:95], v[32:47]
    ds_read_b64_tr_b16 a[192:193], v223 offset:0
    ds_read_b64_tr_b16 a[194:195], v223 offset:2080
    ds_read_b64_tr_b16 a[196:197], v223 offset:4160
    v_mfma_f32_32x32x16_bf16 v[48:63], a[56:59], a[92:95], v[48:63]
    ds_read_b64_tr_b16 a[198:199], v223 offset:6240
    s_waitcnt lgkmcnt(4)
    s_waitcnt vmcnt(7)
    v_mfma_f32_32x32x16_bf16 v[16:31], a[0:3], a[224:227], v[16:31]
    ds_read_b64_tr_b16 a[32:33], v212 offset:0
    ds_read_b64_tr_b16 a[34:35], v212 offset:2080
    ds_read_b64_tr_b16 a[36:37], v213 offset:0
    v_mfma_f32_32x32x16_bf16 v[32:47], a[4:7], a[224:227], v[32:47]
    ds_read_b64_tr_b16 a[38:39], v213 offset:2080
    ds_read_b64_tr_b16 a[40:41], v214 offset:0
    ds_read_b64_tr_b16 a[42:43], v214 offset:2080
    v_mfma_f32_32x32x16_bf16 v[48:63], a[8:11], a[224:227], v[48:63]
    ds_read_b64_tr_b16 a[48:49], v212 offset:4160
    ds_read_b64_tr_b16 a[50:51], v212 offset:6240
    ds_read_b64_tr_b16 a[52:53], v213 offset:4160
    s_waitcnt vmcnt(6)
    v_mfma_f32_32x32x16_bf16 v[16:31], a[16:19], a[228:231], v[16:31]
    ds_read_b64_tr_b16 a[54:55], v213 offset:6240
    ds_read_b64_tr_b16 a[56:57], v214 offset:4160
    ds_read_b64_tr_b16 a[58:59], v214 offset:6240
    v_mfma_f32_32x32x16_bf16 v[32:47], a[20:23], a[228:231], v[32:47]
    ds_read_b64_tr_b16 a[200:201], v215 offset:0
    ds_read_b64_tr_b16 a[202:203], v215 offset:2080
    ds_read_b64_tr_b16 a[204:205], v215 offset:4160
    v_mfma_f32_32x32x16_bf16 v[48:63], a[24:27], a[228:231], v[48:63]
    ds_read_b64_tr_b16 a[206:207], v215 offset:6240
    s_waitcnt lgkmcnt(4)
    s_waitcnt vmcnt(5)
    v_mfma_f32_32x32x16_bf16 v[16:31], a[32:35], a[232:235], v[16:31]
    ds_read_b64_tr_b16 a[0:1], v220 offset:8320
    ds_read_b64_tr_b16 a[2:3], v220 offset:10400
    ds_read_b64_tr_b16 a[4:5], v221 offset:8320
    v_mfma_f32_32x32x16_bf16 v[32:47], a[36:39], a[232:235], v[32:47]
    ds_read_b64_tr_b16 a[6:7], v221 offset:10400
    ds_read_b64_tr_b16 a[8:9], v222 offset:8320
    ds_read_b64_tr_b16 a[10:11], v222 offset:10400
    v_mfma_f32_32x32x16_bf16 v[48:63], a[40:43], a[232:235], v[48:63]
    ds_read_b64_tr_b16 a[16:17], v220 offset:12480
    ds_read_b64_tr_b16 a[18:19], v220 offset:14560
    ds_read_b64_tr_b16 a[20:21], v221 offset:12480
    s_waitcnt vmcnt(4)
    v_mfma_f32_32x32x16_bf16 v[16:31], a[48:51], a[236:239], v[16:31]
    ds_read_b64_tr_b16 a[22:23], v221 offset:14560
    ds_read_b64_tr_b16 a[24:25], v222 offset:12480
    ds_read_b64_tr_b16 a[26:27], v222 offset:14560
    v_mfma_f32_32x32x16_bf16 v[32:47], a[52:55], a[236:239], v[32:47]
    ds_read_b64_tr_b16 a[208:209], v223 offset:8320
    ds_read_b64_tr_b16 a[210:211], v223 offset:10400
    ds_read_b64_tr_b16 a[212:213], v223 offset:12480
    v_mfma_f32_32x32x16_bf16 v[48:63], a[56:59], a[236:239], v[48:63]
    ds_read_b64_tr_b16 a[214:215], v223 offset:14560
    s_waitcnt lgkmcnt(4)
    s_waitcnt vmcnt(3)
    v_mfma_f32_32x32x16_bf16 v[16:31], a[0:3], a[240:243], v[16:31]
    ds_read_b64_tr_b16 a[32:33], v212 offset:8320
    ds_read_b64_tr_b16 a[34:35], v212 offset:10400
    ds_read_b64_tr_b16 a[36:37], v213 offset:8320
    v_mfma_f32_32x32x16_bf16 v[32:47], a[4:7], a[240:243], v[32:47]
    ds_read_b64_tr_b16 a[38:39], v213 offset:10400
    ds_read_b64_tr_b16 a[40:41], v214 offset:8320
    ds_read_b64_tr_b16 a[42:43], v214 offset:10400
    v_mfma_f32_32x32x16_bf16 v[48:63], a[8:11], a[240:243], v[48:63]
    ds_read_b64_tr_b16 a[48:49], v212 offset:12480
    ds_read_b64_tr_b16 a[50:51], v212 offset:14560
    ds_read_b64_tr_b16 a[52:53], v213 offset:12480
    s_waitcnt vmcnt(2)
    v_mfma_f32_32x32x16_bf16 v[16:31], a[16:19], a[244:247], v[16:31]
    ds_read_b64_tr_b16 a[54:55], v213 offset:14560
    ds_read_b64_tr_b16 a[56:57], v214 offset:12480
    ds_read_b64_tr_b16 a[58:59], v214 offset:14560
    v_mfma_f32_32x32x16_bf16 v[32:47], a[20:23], a[244:247], v[32:47]
    ds_read_b64_tr_b16 a[216:217], v215 offset:8320
    ds_read_b64_tr_b16 a[218:219], v215 offset:10400
    ds_read_b64_tr_b16 a[220:221], v215 offset:12480
    v_mfma_f32_32x32x16_bf16 v[48:63], a[24:27], a[244:247], v[48:63]
    ds_read_b64_tr_b16 a[222:223], v215 offset:14560
    s_waitcnt lgkmcnt(4)
    s_waitcnt vmcnt(1)
    v_mfma_f32_32x32x16_bf16 v[16:31], a[32:35], a[248:251], v[16:31]
    v_mfma_f32_32x32x16_bf16 v[32:47], a[36:39], a[248:251], v[32:47]
    v_mfma_f32_32x32x16_bf16 v[48:63], a[40:43], a[248:251], v[48:63]
    s_waitcnt vmcnt(0)
    v_mfma_f32_32x32x16_bf16 v[16:31], a[48:51], a[252:255], v[16:31]
    v_mfma_f32_32x32x16_bf16 v[32:47], a[52:55], a[252:255], v[32:47]
    v_mfma_f32_32x32x16_bf16 v[48:63], a[56:59], a[252:255], v[48:63]
    s_add_u32 s48, s65, 8192
    s_waitcnt lgkmcnt(0)
    v_mfma_f32_32x32x16_bf16 v[64:79], a[96:99], v[80:83], v[64:79]
    s_nop 7
    v_mfma_f32_32x32x16_bf16 v[64:79], a[100:103], v[84:87], v[64:79]
    v_cvt_pk_bf16_f32 v224, v16, v17
    v_cvt_pk_bf16_f32 v225, v18, v19
    v_cvt_pk_bf16_f32 v226, v20, v21
    v_cvt_pk_bf16_f32 v227, v22, v23
    v_min_u32 v224, -2, v224
    v_min_u32 v225, -2, v225
    v_min_u32 v226, -2, v226
    v_min_u32 v227, -2, v227
    v_mfma_f32_32x32x16_bf16 v[64:79], a[104:107], v[88:91], v[64:79]
    buffer_store_dwordx4 v[224:227], v2, s[20:23], s66 offen offset:0 sc1
    v_cvt_pk_bf16_f32 v228, v24, v25
    v_cvt_pk_bf16_f32 v229, v26, v27
    v_cvt_pk_bf16_f32 v230, v28, v29
    v_cvt_pk_bf16_f32 v231, v30, v31
    v_min_u32 v228, -2, v228
    v_min_u32 v229, -2, v229
    v_min_u32 v230, -2, v230
    v_mfma_f32_32x32x16_bf16 v[64:79], a[108:111], v[92:95], v[64:79]
    v_min_u32 v231, -2, v231
    buffer_store_dwordx4 v[228:231], v2, s[20:23], s66 offen offset:1024 sc1
    v_cvt_pk_bf16_f32 v232, v32, v33
    v_cvt_pk_bf16_f32 v233, v34, v35
    v_cvt_pk_bf16_f32 v234, v36, v37
    v_cvt_pk_bf16_f32 v235, v38, v39
    v_min_u32 v232, -2, v232
    v_min_u32 v233, -2, v233
    v_mfma_f32_32x32x16_bf16 v[64:79], a[112:115], v[96:99], v[64:79]
    v_min_u32 v234, -2, v234
    v_min_u32 v235, -2, v235
    buffer_store_dwordx4 v[232:235], v2, s[20:23], s67 offen offset:0 sc1
    v_cvt_pk_bf16_f32 v236, v40, v41
    v_cvt_pk_bf16_f32 v237, v42, v43
    v_cvt_pk_bf16_f32 v238, v44, v45
    v_cvt_pk_bf16_f32 v239, v46, v47
    v_min_u32 v236, -2, v236
    v_mfma_f32_32x32x16_bf16 v[64:79], a[116:119], v[100:103], v[64:79]
    v_min_u32 v237, -2, v237
    v_min_u32 v238, -2, v238
    v_min_u32 v239, -2, v239
    buffer_store_dwordx4 v[236:239], v2, s[20:23], s67 offen offset:1024 sc1
    v_cvt_pk_bf16_f32 v240, v48, v49
    v_cvt_pk_bf16_f32 v241, v50, v51
    v_cvt_pk_bf16_f32 v242, v52, v53
    v_cvt_pk_bf16_f32 v243, v54, v55
    v_mfma_f32_32x32x16_bf16 v[64:79], a[120:123], v[104:107], v[64:79]
    v_min_u32 v240, -2, v240
    v_min_u32 v241, -2, v241
    v_min_u32 v242, -2, v242
    v_min_u32 v243, -2, v243
    buffer_store_dwordx4 v[240:243], v2, s[20:23], s68 offen offset:0 sc1
    v_cvt_pk_bf16_f32 v244, v56, v57
    v_cvt_pk_bf16_f32 v245, v58, v59
    v_cvt_pk_bf16_f32 v246, v60, v61
    v_mfma_f32_32x32x16_bf16 v[64:79], a[124:127], v[108:111], v[64:79]
    v_cvt_pk_bf16_f32 v247, v62, v63
    v_min_u32 v244, -2, v244
    v_min_u32 v245, -2, v245
    v_min_u32 v246, -2, v246
    v_min_u32 v247, -2, v247
    buffer_store_dwordx4 v[244:247], v2, s[20:23], s68 offen offset:1024 sc1
    v_mfma_f32_32x32x16_bf16 v[64:79], a[128:131], v[112:115], v[64:79]
    v_mfma_f32_32x32x16_bf16 v[64:79], a[132:135], v[116:119], v[64:79]
    v_mfma_f32_32x32x16_bf16 v[64:79], a[136:139], v[120:123], v[64:79]
    v_mfma_f32_32x32x16_bf16 v[64:79], a[140:143], v[124:127], v[64:79]
    v_mfma_f32_32x32x16_bf16 v[64:79], a[144:147], v[128:131], v[64:79]
    v_mfma_f32_32x32x16_bf16 v[64:79], a[148:151], v[132:135], v[64:79]
    v_mfma_f32_32x32x16_bf16 v[64:79], a[152:155], v[136:139], v[64:79]
    v_mfma_f32_32x32x16_bf16 v[64:79], a[156:159], v[140:143], v[64:79]
    v_mfma_f32_32x32x16_bf16 v[64:79], a[160:163], a[64:67], v[64:79]
    v_mfma_f32_32x32x16_bf16 v[64:79], a[164:167], a[68:71], v[64:79]
    v_mfma_f32_32x32x16_bf16 v[64:79], a[168:171], a[72:75], v[64:79]
    v_mfma_f32_32x32x16_bf16 v[64:79], a[172:175], a[76:79], v[64:79]
    v_mfma_f32_32x32x16_bf16 v[64:79], a[176:179], a[80:83], v[64:79]
    v_mfma_f32_32x32x16_bf16 v[64:79], a[180:183], a[84:87], v[64:79]
    v_mfma_f32_32x32x16_bf16 v[64:79], a[184:187], a[88:91], v[64:79]
    v_mfma_f32_32x32x16_bf16 v[64:79], a[188:191], a[92:95], v[64:79]
    v_mfma_f32_32x32x16_bf16 v[64:79], a[192:195], a[224:227], v[64:79]
    buffer_load_dwordx4 v[144:147], v2, s[20:23], s65 offen offset:0 sc1
    v_mfma_f32_32x32x16_bf16 v[64:79], a[196:199], a[228:231], v[64:79]
    buffer_load_dwordx4 v[148:151], v2, s[20:23], s65 offen offset:1024 sc1
    v_mfma_f32_32x32x16_bf16 v[64:79], a[200:203], a[232:235], v[64:79]
    buffer_load_dwordx4 v[152:155], v2, s[20:23], s65 offen offset:2048 sc1
    v_mfma_f32_32x32x16_bf16 v[64:79], a[204:207], a[236:239], v[64:79]
    buffer_load_dwordx4 v[156:159], v2, s[20:23], s65 offen offset:3072 sc1
    v_mfma_f32_32x32x16_bf16 v[64:79], a[208:211], a[240:243], v[64:79]
    buffer_load_dwordx4 v[160:163], v3, s[20:23], s65 offen offset:0 sc1
    v_mfma_f32_32x32x16_bf16 v[64:79], a[212:215], a[244:247], v[64:79]
    buffer_load_dwordx4 v[164:167], v3, s[20:23], s65 offen offset:1024 sc1
    v_mfma_f32_32x32x16_bf16 v[64:79], a[216:219], a[248:251], v[64:79]
    v_mfma_f32_32x32x16_bf16 v[64:79], a[220:223], a[252:255], v[64:79]
    s_mov_b32 s47, 0
    s_branch L_in1
L_in0:
    buffer_load_dwordx4 v[144:147], v2, s[20:23], s65 offen offset:0 sc1
    buffer_load_dwordx4 v[148:151], v2, s[20:23], s65 offen offset:1024 sc1
    buffer_load_dwordx4 v[152:155], v2, s[20:23], s65 offen offset:2048 sc1
    buffer_load_dwordx4 v[156:159], v2, s[20:23], s65 offen offset:3072 sc1
    buffer_load_dwordx4 v[160:163], v3, s[20:23], s65 offen offset:0 sc1
    buffer_load_dwordx4 v[164:167], v3, s[20:23], s65 offen offset:1024 sc1
    s_add_u32 s47, s47, 1
L_in1:
    s_waitcnt vmcnt(0)
    v_max_u32 v12, v144, v145
    v_max3_u32 v12, v12, v146, v147
    v_max3_u32 v12, v12, v148, v149
    v_max3_u32 v12, v12, v150, v151
    v_max3_u32 v12, v12, v152, v153
    v_max3_u32 v12, v12, v154, v155
    v_max3_u32 v12, v12, v156, v157
    v_max3_u32 v12, v12, v158, v159
    v_max3_u32 v12, v12, v160, v161
    v_max3_u32 v12, v12, v162, v163
    v_max3_u32 v12, v12, v164, v165
    v_max3_u32 v12, v12, v166, v167
    v_cmp_eq_u32 vcc, -1, v12
    s_cmp_gt_u32 s47, 20000
    s_cbranch_scc1 L_in2
    s_cbranch_vccnz L_in0
L_in2:
    v_lshlrev_b32 v16, 16, v144
    v_and_b32 v17, s45, v144
    v_lshlrev_b32 v18, 16, v145
    v_and_b32 v19, s45, v145
    v_lshlrev_b32 v20, 16, v146
    v_and_b32 v21, s45, v146
    v_lshlrev_b32 v22, 16, v147
    v_and_b32 v23, s45, v147
    v_pk_add_f32 v[64:65], v[64:65], v[16:17]
    v_pk_add_f32 v[66:67], v[66:67], v[18:19]
    v_pk_add_f32 v[68:69], v[68:69], v[20:21]
    v_pk_add_f32 v[70:71], v[70:71], v[22:23]
    v_lshlrev_b32 v16, 16, v152
    v_and_b32 v17, s45, v152
    v_lshlrev_b32 v18, 16, v153
    v_and_b32 v19, s45, v153
    v_lshlrev_b32 v20, 16, v154
    v_and_b32 v21, s45, v154
    v_lshlrev_b32 v22, 16, v155
    v_and_b32 v23, s45, v155
    v_pk_add_f32 v[64:65], v[64:65], v[16:17]
    v_pk_add_f32 v[66:67], v[66:67], v[18:19]
    v_pk_add_f32 v[68:69], v[68:69], v[20:21]
    v_pk_add_f32 v[70:71], v[70:71], v[22:23]
    v_lshlrev_b32 v16, 16, v160
    v_and_b32 v17, s45, v160
    v_lshlrev_b32 v18, 16, v161
    v_and_b32 v19, s45, v161
    v_lshlrev_b32 v20, 16, v162
    v_and_b32 v21, s45, v162
    v_lshlrev_b32 v22, 16, v163
    v_and_b32 v23, s45, v163
    v_pk_add_f32 v[64:65], v[64:65], v[16:17]
    v_pk_add_f32 v[66:67], v[66:67], v[18:19]
    v_pk_add_f32 v[68:69], v[68:69], v[20:21]
    v_pk_add_f32 v[70:71], v[70:71], v[22:23]
    v_cvt_pk_bf16_f32 v32, v64, v65
    v_cvt_pk_bf16_f32 v33, v66, v67
    v_cvt_pk_bf16_f32 v34, v68, v69
    v_cvt_pk_bf16_f32 v35, v70, v71
    s_nop 1
    v_permlane32_swap_b32 v32, v34
    v_permlane32_swap_b32 v33, v35
    buffer_store_dwordx4 v[32:35], v204, s[28:31], s69 offen offset:0
    v_lshlrev_b32 v16, 16, v148
    v_and_b32 v17, s45, v148
    v_lshlrev_b32 v18, 16, v149
    v_and_b32 v19, s45, v149
    v_lshlrev_b32 v20, 16, v150
    v_and_b32 v21, s45, v150
    v_lshlrev_b32 v22, 16, v151
    v_and_b32 v23, s45, v151
    v_pk_add_f32 v[72:73], v[72:73], v[16:17]
    v_pk_add_f32 v[74:75], v[74:75], v[18:19]
    v_pk_add_f32 v[76:77], v[76:77], v[20:21]
    v_pk_add_f32 v[78:79], v[78:79], v[22:23]
    v_lshlrev_b32 v16, 16, v156
    v_and_b32 v17, s45, v156
    v_lshlrev_b32 v18, 16, v157
    v_and_b32 v19, s45, v157
    v_lshlrev_b32 v20, 16, v158
    v_and_b32 v21, s45, v158
    v_lshlrev_b32 v22, 16, v159
    v_and_b32 v23, s45, v159
    v_pk_add_f32 v[72:73], v[72:73], v[16:17]
    v_pk_add_f32 v[74:75], v[74:75], v[18:19]
    v_pk_add_f32 v[76:77], v[76:77], v[20:21]
    v_pk_add_f32 v[78:79], v[78:79], v[22:23]
    v_lshlrev_b32 v16, 16, v164
    v_and_b32 v17, s45, v164
    v_lshlrev_b32 v18, 16, v165
    v_and_b32 v19, s45, v165
    v_lshlrev_b32 v20, 16, v166
    v_and_b32 v21, s45, v166
    v_lshlrev_b32 v22, 16, v167
    v_and_b32 v23, s45, v167
    v_pk_add_f32 v[72:73], v[72:73], v[16:17]
    v_pk_add_f32 v[74:75], v[74:75], v[18:19]
    v_pk_add_f32 v[76:77], v[76:77], v[20:21]
    v_pk_add_f32 v[78:79], v[78:79], v[22:23]
    v_cvt_pk_bf16_f32 v36, v72, v73
    v_cvt_pk_bf16_f32 v37, v74, v75
    v_cvt_pk_bf16_f32 v38, v76, v77
    v_cvt_pk_bf16_f32 v39, v78, v79
    s_nop 1
    v_permlane32_swap_b32 v36, v38
    v_permlane32_swap_b32 v37, v39
    buffer_store_dwordx4 v[36:39], v204, s[28:31], s69 offen offset:32
L_idle:
L_end:
    s_endpgm
L_blk:
    s_mov_b32 s47, 0
L_bk0:
    s_buffer_load_dword s50, s[20:23], s70 offset:0 glc
    s_buffer_load_dword s51, s[20:23], s70 offset:4096 glc
    s_buffer_load_dword s52, s[20:23], s70 offset:8192 glc
    s_buffer_load_dword s53, s[20:23], s70 offset:12288 glc
    s_add_u32 s47, s47, 1
    s_waitcnt lgkmcnt(0)
    s_cmp_eq_u64 s[50:51], s[100:101]
    s_cbranch_scc0 L_bk1
    s_cmp_eq_u64 s[52:53], s[100:101]
    s_cbranch_scc1 L_blkr
L_bk1:
    s_cmp_le_u32 s47, 40
    s_cbranch_scc1 L_bk0
L_bk2:
    buffer_load_dword v208, v206, s[20:23], s70 offen sc1
    s_add_u32 s47, s47, 1
    s_waitcnt vmcnt(0)
    v_cmp_ne_u32 vcc, v209, v208
    s_cmp_gt_u32 s47, 20000
    s_cbranch_scc1 L_blkr
    s_cbranch_vccnz L_bk2
    s_branch L_blkr
L_fins:
    v_pk_mul_f32 v[16:17], v[16:17], v[198:199]
    v_pk_mul_f32 v[18:19], v[18:19], v[198:199]
    v_pk_mul_f32 v[20:21], v[20:21], v[198:199]
    v_pk_mul_f32 v[22:23], v[22:23], v[198:199]
    v_pk_mul_f32 v[24:25], v[24:25], v[198:199]
    v_pk_mul_f32 v[26:27], v[26:27], v[198:199]
    v_pk_mul_f32 v[28:29], v[28:29], v[198:199]
    v_pk_mul_f32 v[30:31], v[30:31], v[198:199]
    v_cvt_pk_bf16_f32 v96, v16, v17
    v_cvt_pk_bf16_f32 v97, v18, v19
    v_cvt_pk_bf16_f32 v98, v20, v21
    v_cvt_pk_bf16_f32 v99, v22, v23
    v_cvt_pk_bf16_f32 v100, v24, v25
    v_cvt_pk_bf16_f32 v101, v26, v27
    v_cvt_pk_bf16_f32 v102, v28, v29
    v_cvt_pk_bf16_f32 v103, v30, v31
    buffer_store_dwordx4 v[96:99], v2, s[20:23], s46 offen offset:0 sc1
    buffer_store_dwordx4 v[100:103], v2, s[20:23], s46 offen offset:1024 sc1
    v_pk_mul_f32 v[32:33], v[32:33], v[198:199]
    v_pk_mul_f32 v[34:35], v[34:35], v[198:199]
    v_pk_mul_f32 v[36:37], v[36:37], v[198:199]
    v_pk_mul_f32 v[38:39], v[38:39], v[198:199]
    v_pk_mul_f32 v[40:41], v[40:41], v[198:199]
    v_pk_mul_f32 v[42:43], v[42:43], v[198:199]
    v_pk_mul_f32 v[44:45], v[44:45], v[198:199]
    v_pk_mul_f32 v[46:47], v[46:47], v[198:199]
    v_cvt_pk_bf16_f32 v104, v32, v33
    v_cvt_pk_bf16_f32 v105, v34, v35
    v_cvt_pk_bf16_f32 v106, v36, v37
    v_cvt_pk_bf16_f32 v107, v38, v39
    v_cvt_pk_bf16_f32 v108, v40, v41
    v_cvt_pk_bf16_f32 v109, v42, v43
    v_cvt_pk_bf16_f32 v110, v44, v45
    v_cvt_pk_bf16_f32 v111, v46, v47
    buffer_store_dwordx4 v[104:107], v2, s[20:23], s46 offen offset:2048 sc1
    buffer_store_dwordx4 v[108:111], v2, s[20:23], s46 offen offset:3072 sc1
    v_pk_mul_f32 v[48:49], v[48:49], v[198:199]
    v_pk_mul_f32 v[50:51], v[50:51], v[198:199]
    v_pk_mul_f32 v[52:53], v[52:53], v[198:199]
    v_pk_mul_f32 v[54:55], v[54:55], v[198:199]
    v_pk_mul_f32 v[56:57], v[56:57], v[198:199]
    v_pk_mul_f32 v[58:59], v[58:59], v[198:199]
    v_pk_mul_f32 v[60:61], v[60:61], v[198:199]
    v_pk_mul_f32 v[62:63], v[62:63], v[198:199]
    v_cvt_pk_bf16_f32 v128, v48, v49
    v_cvt_pk_bf16_f32 v129, v50, v51
    v_cvt_pk_bf16_f32 v130, v52, v53
    v_cvt_pk_bf16_f32 v131, v54, v55
    v_cvt_pk_bf16_f32 v132, v56, v57
    v_cvt_pk_bf16_f32 v133, v58, v59
    v_cvt_pk_bf16_f32 v134, v60, v61
    v_cvt_pk_bf16_f32 v135, v62, v63
    buffer_store_dwordx4 v[128:131], v3, s[20:23], s46 offen offset:0 sc1
    buffer_store_dwordx4 v[132:135], v3, s[20:23], s46 offen offset:1024 sc1
    v_pk_mul_f32 v[64:65], v[64:65], v[198:199]
    v_pk_mul_f32 v[66:67], v[66:67], v[198:199]
    v_pk_mul_f32 v[68:69], v[68:69], v[198:199]
    v_pk_mul_f32 v[70:71], v[70:71], v[198:199]
    v_pk_mul_f32 v[72:73], v[72:73], v[198:199]
    v_pk_mul_f32 v[74:75], v[74:75], v[198:199]
    v_pk_mul_f32 v[76:77], v[76:77], v[198:199]
    v_pk_mul_f32 v[78:79], v[78:79], v[198:199]
    v_cvt_pk_bf16_f32 v136, v64, v65
    v_cvt_pk_bf16_f32 v137, v66, v67
    v_cvt_pk_bf16_f32 v138, v68, v69
    v_cvt_pk_bf16_f32 v139, v70, v71
    v_cvt_pk_bf16_f32 v140, v72, v73
    v_cvt_pk_bf16_f32 v141, v74, v75
    v_cvt_pk_bf16_f32 v142, v76, v77
    v_cvt_pk_bf16_f32 v143, v78, v79
    buffer_store_dwordx4 v[136:139], v3, s[20:23], s46 offen offset:2048 sc1
    buffer_store_dwordx4 v[140:143], v3, s[20:23], s46 offen offset:3072 sc1
    s_branch L_finr
L_qbody:
    s_waitcnt lgkmcnt(0)
    s_barrier
    v_mfma_f32_32x32x16_bf16 v[16:31], a[20:23], a[28:31], v[16:31]
    ds_read_b64_tr_b16 a[0:1], v7 offset:0
    ds_read_b64_tr_b16 a[2:3], v7 offset:512
    ds_read_b128 a[8:11], v192 offset:0
    v_mfma_f32_32x32x16_bf16 v[32:47], a[20:23], a[32:35], v[32:47]
    ds_read_b128 a[12:15], v192 offset:4096
    ds_read_b128 a[16:19], v192 offset:8192
    v_mfma_f32_32x32x16_bf16 v[48:63], a[20:23], a[36:39], v[48:63]
    ds_read_b64_tr_b16 a[4:5], v8 offset:0
    ds_read_b64_tr_b16 a[6:7], v8 offset:512
    v_mfma_f32_32x32x16_bf16 v[64:79], a[24:27], a[28:31], v[64:79]
    s_cbranch_vccz L_qs0
    s_mov_b32 m0, s52
    s_nop 0
    buffer_load_dwordx4 v4, s[16:19], s50 offen lds
L_qs0:
    v_mfma_f32_32x32x16_bf16 v[80:95], a[24:27], a[32:35], v[80:95]
    s_cbranch_vccz L_qs1
    s_add_u32 m0, m0, 1024
    s_add_u32 s50, s50, 65536
    buffer_load_dwordx4 v4, s[16:19], s50 offen lds
L_qs1:
    v_mfma_f32_32x32x16_bf16 v[96:111], a[24:27], a[36:39], v[96:111]
    s_cbranch_vccz L_qs2
    s_add_u32 m0, m0, 1024
    s_add_u32 s50, s50, 65536
    buffer_load_dwordx4 v4, s[16:19], s50 offen lds
L_qs2:
    s_waitcnt lgkmcnt(0)
    v_mfma_f32_32x32x16_bf16 v[16:31], a[0:3], a[8:11], v[16:31]
    ds_read_b64_tr_b16 a[20:21], v7 offset:2048
    ds_read_b64_tr_b16 a[22:23], v7 offset:2560
    ds_read_b128 a[28:31], v193 offset:0
    v_mfma_f32_32x32x16_bf16 v[32:47], a[0:3], a[12:15], v[32:47]
    ds_read_b128 a[32:35], v193 offset:4096
    ds_read_b128 a[36:39], v193 offset:8192
    v_mfma_f32_32x32x16_bf16 v[48:63], a[0:3], a[16:19], v[48:63]
    ds_read_b64_tr_b16 a[24:25], v8 offset:2048
    ds_read_b64_tr_b16 a[26:27], v8 offset:2560
    v_mfma_f32_32x32x16_bf16 v[64:79], a[4:7], a[8:11], v[64:79]
    s_cbranch_vccz L_qs3
    s_add_u32 m0, m0, 1024
    s_add_u32 s50, s50, 65536
    buffer_load_dwordx4 v4, s[16:19], s50 offen lds
L_qs3:
    v_mfma_f32_32x32x16_bf16 v[80:95], a[4:7], a[12:15], v[80:95]
    s_cbranch_vccz L_qs4
    s_add_u32 m0, m0, 1024
    s_add_u32 s50, s50, 65536
    buffer_load_dwordx4 v4, s[16:19], s50 offen lds
L_qs4:
    v_mfma_f32_32x32x16_bf16 v[96:111], a[4:7], a[16:19], v[96:111]
    s_cbranch_vccz L_qs5
    s_add_u32 m0, m0, 1024
    s_add_u32 s50, s50, 65536
    buffer_load_dwordx4 v4, s[16:19], s50 offen lds
L_qs5:
    s_waitcnt lgkmcnt(0)
    v_mfma_f32_32x32x16_bf16 v[16:31], a[20:23], a[28:31], v[16:31]
    ds_read_b64_tr_b16 a[0:1], v7 offset:4096
    ds_read_b64_tr_b16 a[2:3], v7 offset:4608
    ds_read_b128 a[8:11], v194 offset:0
    v_mfma_f32_32x32x16_bf16 v[32:47], a[20:23], a[32:35], v[32:47]
    ds_read_b128 a[12:15], v194 offset:4096
    ds_read_b128 a[16:19], v194 offset:8192
    v_mfma_f32_32x32x16_bf16 v[48:63], a[20:23], a[36:39], v[48:63]
    ds_read_b64_tr_b16 a[4:5], v8 offset:4096
    ds_read_b64_tr_b16 a[6:7], v8 offset:4608
    v_mfma_f32_32x32x16_bf16 v[64:79], a[24:27], a[28:31], v[64:79]
    s_cbranch_vccz L_qs6
    s_add_u32 m0, m0, 1024
    s_add_u32 s50, s50, 65536
    buffer_load_dwordx4 v4, s[16:19], s50 offen lds
L_qs6:
    v_mfma_f32_32x32x16_bf16 v[80:95], a[24:27], a[32:35], v[80:95]
    s_cbranch_vccz L_qs7
    s_add_u32 m0, m0, 1024
    s_add_u32 s50, s50, 65536
    buffer_load_dwordx4 v4, s[16:19], s50 offen lds
L_qs7:
    v_mfma_f32_32x32x16_bf16 v[96:111], a[24:27], a[36:39], v[96:111]
    s_cbranch_vccz L_qs8
    s_mov_b32 m0, s53
    s_add_u32 s50, s50, 65536
    buffer_load_dwordx4 v5, s[4:7], s51 offen lds
L_qs8:
    s_waitcnt lgkmcnt(0)
    v_mfma_f32_32x32x16_bf16 v[16:31], a[0:3], a[8:11], v[16:31]
    ds_read_b64_tr_b16 a[20:21], v7 offset:6144
    ds_read_b64_tr_b16 a[22:23], v7 offset:6656
    ds_read_b128 a[28:31], v195 offset:0
    v_mfma_f32_32x32x16_bf16 v[32:47], a[0:3], a[12:15], v[32:47]
    ds_read_b128 a[32:35], v195 offset:4096
    ds_read_b128 a[36:39], v195 offset:8192
    v_mfma_f32_32x32x16_bf16 v[48:63], a[0:3], a[16:19], v[48:63]
    ds_read_b64_tr_b16 a[24:25], v8 offset:6144
    ds_read_b64_tr_b16 a[26:27], v8 offset:6656
    v_mfma_f32_32x32x16_bf16 v[64:79], a[4:7], a[8:11], v[64:79]
    s_cbranch_vccz L_qs9
    s_add_u32 m0, m0, 4096
    s_add_u32 s51, s51, 40960
    buffer_load_dwordx4 v5, s[4:7], s51 offen lds
L_qs9:
    v_mfma_f32_32x32x16_bf16 v[80:95], a[4:7], a[12:15], v[80:95]
    s_cbranch_vccz L_qs10
    s_add_u32 m0, m0, 4096
    s_add_u32 s51, s51, 40960
    buffer_load_dwordx4 v5, s[4:7], s51 offen lds
    s_sub_u32 s51, s51, 81792
L_qs10:
    v_mfma_f32_32x32x16_bf16 v[96:111], a[4:7], a[16:19], v[96:111]
    s_add_u32 s82, s82, 1
    s_cmp_eq_u32 s82, 3
    s_cselect_b32 s47, 135168, 0
    s_cselect_b32 s82, 0, s82
    s_sub_u32 s47, 45056, s47
    v_add_u32 v7, s47, v7
    v_add_u32 v8, s47, v8
    v_add_u32 v192, s47, v192
    v_add_u32 v193, s47, v193
    v_add_u32 v194, s47, v194
    v_add_u32 v195, s47, v195
    s_cbranch_vccz L_qsr
    s_add_u32 s52, s52, 45056
    s_add_u32 s53, s53, 45056
    s_cmp_ge_u32 s52, 135168
    s_cselect_b32 s47, 135168, 0
    s_sub_u32 s52, s52, s47
    s_sub_u32 s53, s53, s47
L_qsr:
    s_setpc_b64 s[40:41]
L_hookc:
    s_cmp_eq_u32 s39, 0
    s_cbranch_scc1 L_dump
    s_cmp_ge_u32 s45, 3
    s_cbranch_scc1 L_hpub
    s_getreg_b32 s47, hwreg(HW_REG_IB_STS)
    s_and_b32 s47, s47, 0xc0000f
    s_cbranch_scc1 L_hret
L_hpub:
    s_waitcnt vmcnt(0)
    s_mov_b64 exec, 1
    v_mov_b32 v208, 1
    ds_add_rtn_u32 v208, v211, v208 offset:4
    s_lshl_b32 s47, s36, 7
    s_waitcnt lgkmcnt(0)
    v_readfirstlane_b32 s46, v208
    s_mov_b64 exec, -1
    s_cmp_eq_u32 s46, 2
    s_cbranch_scc0 L_pubh
    s_sub_u32 s47, 25166208, s47
    buffer_store_dword v209, v210, s[20:23], s47 offen sc1
L_pubh:
    s_mov_b32 s78, 0
L_hret:
    s_setpc_b64 s[40:41]
L_dump:
    v_add_u32 v198, s77, v2
    s_add_u32 s77, s77, 24960
    s_cmp_ge_u32 s77, s58
    s_cselect_b32 s46, 74880, 0
    s_sub_u32 s77, s77, s46
    s_add_u32 s79, s79, 1
    s_waitcnt vmcnt(0)
    s_cmp_eq_u32 s79, 1
    s_cbranch_scc0 L_dm1
    ds_write_b128 v198, a[96:99] offset:0
    ds_write_b128 v198, a[100:103] offset:1040
    ds_write_b128 v198, a[104:107] offset:2080
    ds_write_b128 v198, a[108:111] offset:3120
    ds_write_b128 v198, a[112:115] offset:4160
    ds_write_b128 v198, a[116:119] offset:5200
    ds_write_b128 v198, a[120:123] offset:6240
    ds_write_b128 v198, a[124:127] offset:7280
    s_setpc_b64 s[40:41]
L_dm1:
    s_cmp_eq_u32 s79, 2
    s_cbranch_scc0 L_dm2
    ds_write_b128 v198, a[128:131] offset:0
    ds_write_b128 v198, a[132:135] offset:1040
    ds_write_b128 v198, a[136:139] offset:2080
    ds_write_b128 v198, a[140:143] offset:3120
    ds_write_b128 v198, a[144:147] offset:4160
    ds_write_b128 v198, a[148:151] offset:5200
    ds_write_b128 v198, a[152:155] offset:6240
    ds_write_b128 v198, a[156:159] offset:7280
    s_setpc_b64 s[40:41]
L_dm2:
    ds_write_b128 v198, a[160:163] offset:0
    ds_write_b128 v198, a[164:167] offset:1040
    ds_write_b128 v198, a[168:171] offset:2080
    ds_write_b128 v198, a[172:175] offset:3120
    ds_write_b128 v198, a[176:179] offset:4160
    ds_write_b128 v198, a[180:183] offset:5200
    ds_write_b128 v198, a[184:187] offset:6240
    ds_write_b128 v198, a[188:191] offset:7280
    s_setpc_b64 s[40:41]
L_ldK:
    s_mov_b32 m0, s58
    s_add_u32 s46, s57, 4096
    buffer_load_dwordx4 v6, s[8:11], s57 offen offset:0 nt lds
    s_add_u32 m0, m0, 16
    s_nop 0
    buffer_load_dwordx4 v6, s[8:11], s57 offen offset:1024 nt lds
    s_add_u32 m0, m0, 16
    s_nop 0
    buffer_load_dwordx4 v6, s[8:11], s57 offen offset:2048 nt lds
    s_add_u32 m0, m0, 16
    s_nop 0
    buffer_load_dwordx4 v6, s[8:11], s57 offen offset:3072 nt lds
    s_add_u32 m0, m0, 4112
    s_nop 0
    buffer_load_dwordx4 v6, s[8:11], s46 offen offset:0 nt lds
    s_add_u32 m0, m0, 16
    s_nop 0
    buffer_load_dwordx4 v6, s[8:11], s46 offen offset:1024 nt lds
    s_add_u32 m0, m0, 16
    s_nop 0
    buffer_load_dwordx4 v6, s[8:11], s46 offen offset:2048 nt lds
    s_add_u32 m0, m0, 16
    s_nop 0
    buffer_load_dwordx4 v6, s[8:11], s46 offen offset:3072 nt lds
    s_add_u32 s57, s57, 8192
    s_add_u32 s58, s58, 8320
    s_cmp_eq_u32 s58, 74880
    s_cselect_b32 s58, 0, s58
    s_setpc_b64 s[40:41]
L_ldV:
    s_mov_b32 m0, s60
    s_add_u32 s46, s59, 4096
    buffer_load_dwordx4 v6, s[12:15], s59 offen offset:0 nt lds
    s_add_u32 m0, m0, 16
    s_nop 0
    buffer_load_dwordx4 v6, s[12:15], s59 offen offset:1024 nt lds
    s_add_u32 m0, m0, 16
    s_nop 0
    buffer_load_dwordx4 v6, s[12:15], s59 offen offset:2048 nt lds
    s_add_u32 m0, m0, 16
    s_nop 0
    buffer_load_dwordx4 v6, s[12:15], s59 offen offset:3072 nt lds
    s_add_u32 m0, m0, 4112
    s_nop 0
    buffer_load_dwordx4 v6, s[12:15], s46 offen offset:0 nt lds
    s_add_u32 m0, m0, 16
    s_nop 0
    buffer_load_dwordx4 v6, s[12:15], s46 offen offset:1024 nt lds
    s_add_u32 m0, m0, 16
    s_nop 0
    buffer_load_dwordx4 v6, s[12:15], s46 offen offset:2048 nt lds
    s_add_u32 m0, m0, 16
    s_nop 0
    buffer_load_dwordx4 v6, s[12:15], s46 offen offset:3072 nt lds
    s_add_u32 s59, s59, 8192
    s_add_u32 s60, s60, 8320
    s_cmp_eq_u32 s60, 149760
    s_cselect_b32 s60, 74880, s60
    s_setpc_b64 s[40:41]
L_ldW:
    s_lshr_b32 s46, s44, 2
    s_lshl2_add_u32 s46, s46, s44
    s_mul_i32 s46, s46, 40960
    s_add_u32 s46, s46, s79
    buffer_load_dwordx4 v207, s[24:27], s46 offen lds
    s_add_u32 m0, m0, 1040
    s_add_u32 s46, s46, 5120
    buffer_load_dwordx4 v207, s[24:27], s46 offen lds
    s_add_u32 m0, m0, 1040
    s_add_u32 s46, s46, 5120
    buffer_load_dwordx4 v207, s[24:27], s46 offen lds
    s_add_u32 m0, m0, 1040
    s_add_u32 s46, s46, 5120
    buffer_load_dwordx4 v207, s[24:27], s46 offen lds
    s_add_u32 m0, m0, 1040
    s_add_u32 s46, s46, 5120
    buffer_load_dwordx4 v207, s[24:27], s46 offen lds
    s_add_u32 m0, m0, 1040
    s_add_u32 s46, s46, 5120
    buffer_load_dwordx4 v207, s[24:27], s46 offen lds
    s_add_u32 m0, m0, 1040
    s_add_u32 s46, s46, 5120
    buffer_load_dwordx4 v207, s[24:27], s46 offen lds
    s_add_u32 m0, m0, 1040
    s_add_u32 s46, s46, 5120
    buffer_load_dwordx4 v207, s[24:27], s46 offen lds
    s_add_u32 s44, s44, 1
    s_and_b32 s44, s44, 15
    s_setpc_b64 s[40:41]
L_w3:
    s_lshl_b32 s46, s38, 4
    s_add_u32 s46, s46, s37
    s_lshl_b32 s57, s46, 18
    s_add_u32 s57, s57, s63
    s_mov_b32 s59, s57
    s_mov_b32 s58, 33280
    s_mov_b32 s60, 108160
    s_mov_b32 s72, s8
    s_mov_b32 s73, s9
    s_mov_b32 s74, 67108864
    s_mov_b32 s75, 0x00020000
    s_mov_b32 s54, 2130706432
    v_cmp_eq_u32 vcc, 0, v1
    v_mov_b32 v9, 2130706432
    v_mov_b32 v10, 0
    v_cndmask_b32 v11, v9, v10, vcc
    s_mov_b32 s49, 25182208
    s_cmp_lg_u32 s2, 0
    s_cbranch_scc1 L_non0
    s_buffer_load_dword s100, s[20:23], s49
L_non0:
L_hv0:
    s_waitcnt vmcnt(11)
    s_mov_b64 vcc, -1
    s_call_b64 s[40:41], L_qbody
    s_cmp_lg_u32 s2, 0
    s_cbranch_scc1 L_non10
    s_add_u32 s100, s100, 1
    s_max_u32 s100, s100, 1
    v_mov_b32 v9, s100
    buffer_store_dword v9, v11, s[20:23], s49 offen sc1
    buffer_store_dword v9, v11, s[32:35], 0 offen sc1
L_non10:
    s_add_u32 s46, s57, 4096
    buffer_load_dwordx4 a[64:67], v6, s[8:11], s57 offen offset:0 nt
    buffer_load_dwordx4 a[68:71], v6, s[8:11], s57 offen offset:1024 nt
    buffer_load_dwordx4 a[72:75], v6, s[8:11], s57 offen offset:2048 nt
    buffer_load_dwordx4 a[76:79], v6, s[8:11], s57 offen offset:3072 nt
    buffer_load_dwordx4 a[80:83], v6, s[8:11], s46 offen offset:0 nt
    buffer_load_dwordx4 a[84:87], v6, s[8:11], s46 offen offset:1024 nt
    buffer_load_dwordx4 a[88:91], v6, s[8:11], s46 offen offset:2048 nt
    buffer_load_dwordx4 a[92:95], v6, s[8:11], s46 offen offset:3072 nt
    s_add_u32 s57, s57, 8192
    s_waitcnt vmcnt(19)
    s_mov_b64 vcc, -1
    s_call_b64 s[40:41], L_qbody
    s_add_u32 s46, s57, 4096
    buffer_load_dwordx4 a[96:99], v6, s[8:11], s57 offen offset:0 nt
    buffer_load_dwordx4 a[100:103], v6, s[8:11], s57 offen offset:1024 nt
    buffer_load_dwordx4 a[104:107], v6, s[8:11], s57 offen offset:2048 nt
    buffer_load_dwordx4 a[108:111], v6, s[8:11], s57 offen offset:3072 nt
    buffer_load_dwordx4 a[112:115], v6, s[8:11], s46 offen offset:0 nt
    buffer_load_dwordx4 a[116:119], v6, s[8:11], s46 offen offset:1024 nt
    buffer_load_dwordx4 a[120:123], v6, s[8:11], s46 offen offset:2048 nt
    buffer_load_dwordx4 a[124:127], v6, s[8:11], s46 offen offset:3072 nt
    s_add_u32 s57, s57, 8192
    s_waitcnt vmcnt(27)
    s_mov_b64 vcc, -1
    s_call_b64 s[40:41], L_qbody
    s_add_u32 s46, s57, 4096
    buffer_load_dwordx4 a[128:131], v6, s[8:11], s57 offen offset:0 nt
    buffer_load_dwordx4 a[132:135], v6, s[8:11], s57 offen offset:1024 nt
    buffer_load_dwordx4 a[136:139], v6, s[8:11], s57 offen offset:2048 nt
    buffer_load_dwordx4 a[140:143], v6, s[8:11], s57 offen offset:3072 nt
    buffer_load_dwordx4 a[144:147], v6, s[8:11], s46 offen offset:0 nt
    buffer_load_dwordx4 a[148:151], v6, s[8:11], s46 offen offset:1024 nt
    buffer_load_dwordx4 a[152:155], v6, s[8:11], s46 offen offset:2048 nt
    buffer_load_dwordx4 a[156:159], v6, s[8:11], s46 offen offset:3072 nt
    s_add_u32 s57, s57, 8192
    s_waitcnt vmcnt(27)
    s_mov_b64 vcc, -1
    s_call_b64 s[40:41], L_qbody
    s_add_u32 s46, s57, 4096
    buffer_load_dwordx4 a[160:163], v6, s[8:11], s57 offen offset:0 nt
    buffer_load_dwordx4 a[164:167], v6, s[8:11], s57 offen offset:1024 nt
    buffer_load_dwordx4 a[168:171], v6, s[8:11], s57 offen offset:2048 nt
    buffer_load_dwordx4 a[172:175], v6, s[8:11], s57 offen offset:3072 nt
    buffer_load_dwordx4 a[176:179], v6, s[8:11], s46 offen offset:0 nt
    buffer_load_dwordx4 a[180:183], v6, s[8:11], s46 offen offset:1024 nt
    buffer_load_dwordx4 a[184:187], v6, s[8:11], s46 offen offset:2048 nt
    buffer_load_dwordx4 a[188:191], v6, s[8:11], s46 offen offset:3072 nt
    s_add_u32 s57, s57, 8192
    s_waitcnt vmcnt(27)
    s_mov_b64 vcc, -1
    s_call_b64 s[40:41], L_qbody
    s_add_u32 s46, s59, 4096
    buffer_load_dwordx4 a[192:195], v6, s[12:15], s59 offen offset:0 nt
    buffer_load_dwordx4 a[196:199], v6, s[12:15], s59 offen offset:1024 nt
    buffer_load_dwordx4 a[200:203], v6, s[12:15], s59 offen offset:2048 nt
    buffer_load_dwordx4 a[204:207], v6, s[12:15], s59 offen offset:3072 nt
    buffer_load_dwordx4 a[208:211], v6, s[12:15], s46 offen offset:0 nt
    buffer_load_dwordx4 a[212:215], v6, s[12:15], s46 offen offset:1024 nt
    buffer_load_dwordx4 a[216:219], v6, s[12:15], s46 offen offset:2048 nt
    buffer_load_dwordx4 a[220:223], v6, s[12:15], s46 offen offset:3072 nt
    s_add_u32 s59, s59, 8192
    s_waitcnt vmcnt(27)
    s_mov_b64 vcc, -1
    s_call_b64 s[40:41], L_qbody
    s_add_u32 s46, s57, 4096
    buffer_load_dwordx4 a[224:227], v6, s[8:11], s57 offen offset:0 nt
    buffer_load_dwordx4 a[228:231], v6, s[8:11], s57 offen offset:1024 nt
    buffer_load_dwordx4 a[232:235], v6, s[8:11], s57 offen offset:2048 nt
    buffer_load_dwordx4 a[236:239], v6, s[8:11], s57 offen offset:3072 nt
    buffer_load_dwordx4 a[240:243], v6, s[8:11], s46 offen offset:0 nt
    buffer_load_dwordx4 a[244:247], v6, s[8:11], s46 offen offset:1024 nt
    buffer_load_dwordx4 a[248:251], v6, s[8:11], s46 offen offset:2048 nt
    buffer_load_dwordx4 a[252:255], v6, s[8:11], s46 offen offset:3072 nt
    s_add_u32 s57, s57, 8192
    s_waitcnt vmcnt(27)
    s_mov_b64 vcc, -1
    s_call_b64 s[40:41], L_qbody
    s_add_u32 s46, s59, 4096
    buffer_load_dwordx4 v[112:115], v6, s[12:15], s59 offen offset:0 nt
    buffer_load_dwordx4 v[116:119], v6, s[12:15], s59 offen offset:1024 nt
    buffer_load_dwordx4 v[120:123], v6, s[12:15], s59 offen offset:2048 nt
    buffer_load_dwordx4 v[124:127], v6, s[12:15], s59 offen offset:3072 nt
    buffer_load_dwordx4 v[128:131], v6, s[12:15], s46 offen offset:0 nt
    buffer_load_dwordx4 v[132:135], v6, s[12:15], s46 offen offset:1024 nt
    buffer_load_dwordx4 v[136:139], v6, s[12:15], s46 offen offset:2048 nt
    buffer_load_dwordx4 v[140:143], v6, s[12:15], s46 offen offset:3072 nt
    s_add_u32 s59, s59, 8192
    s_waitcnt vmcnt(27)
    s_mov_b64 vcc, -1
    s_call_b64 s[40:41], L_qbody
    s_add_u32 s46, s57, 4096
    buffer_load_dwordx4 v[144:147], v6, s[8:11], s57 offen offset:0 nt
    buffer_load_dwordx4 v[148:151], v6, s[8:11], s57 offen offset:1024 nt
    buffer_load_dwordx4 v[152:155], v6, s[8:11], s57 offen offset:2048 nt
    buffer_load_dwordx4 v[156:159], v6, s[8:11], s57 offen offset:3072 nt
    buffer_load_dwordx4 v[160:163], v6, s[8:11], s46 offen offset:0 nt
    buffer_load_dwordx4 v[164:167], v6, s[8:11], s46 offen offset:1024 nt
    buffer_load_dwordx4 v[168:171], v6, s[8:11], s46 offen offset:2048 nt
    buffer_load_dwordx4 v[172:175], v6, s[8:11], s46 offen offset:3072 nt
    s_add_u32 s57, s57, 8192
    s_waitcnt vmcnt(27)
    s_mov_b64 vcc, 0
    s_mov_b32 s55, 1
    v_add_u32 v9, 58240, v2
    s_call_b64 s[40:41], L_qbody
    v_add_u32 v9, 58240, v2
    ds_write_b128 v9, a[64:67] offset:0
    ds_write_b128 v9, a[68:71] offset:1040
    ds_write_b128 v9, a[72:75] offset:2080
    ds_write_b128 v9, a[76:79] offset:3120
    ds_write_b128 v9, a[80:83] offset:4160
    ds_write_b128 v9, a[84:87] offset:5200
    ds_write_b128 v9, a[88:91] offset:6240
    ds_write_b128 v9, a[92:95] offset:7280
    v_add_u32 v9, 66560, v2
    ds_write_b128 v9, a[96:99] offset:0
    ds_write_b128 v9, a[100:103] offset:1040
    ds_write_b128 v9, a[104:107] offset:2080
    ds_write_b128 v9, a[108:111] offset:3120
    ds_write_b128 v9, a[112:115] offset:4160
    ds_write_b128 v9, a[116:119] offset:5200
    ds_write_b128 v9, a[120:123] offset:6240
    ds_write_b128 v9, a[124:127] offset:7280
    s_waitcnt vmcnt(8)
    s_mov_b64 vcc, 0
    s_mov_b32 s55, 2
    v_add_u32 v9, 66560, v2
    s_call_b64 s[40:41], L_qbody
    s_mov_b32 s72, s12
    s_mov_b32 s73, s13
    s_add_u32 s54, s59, 16384
    s_mov_b32 s55, 91520
    s_add_u32 s59, s59, 24576
    s_mov_b32 s60, 99840
    s_branch L_qend
L_w3a:
    ds_write_b128 v2, a[128:131] offset:0
    ds_write_b128 v2, a[132:135] offset:1040
    ds_write_b128 v2, a[136:139] offset:2080
    ds_write_b128 v2, a[140:143] offset:3120
    ds_write_b128 v2, a[144:147] offset:4160
    ds_write_b128 v2, a[148:151] offset:5200
    ds_write_b128 v2, a[152:155] offset:6240
    ds_write_b128 v2, a[156:159] offset:7280
    s_call_b64 s[40:41], L_ldK
    s_call_b64 s[40:41], L_ldK
    s_add_u32 s57, s57, 8192
    s_add_u32 s58, s58, 8320
    s_cmp_eq_u32 s58, 74880
    s_cselect_b32 s58, 0, s58
    s_waitcnt lgkmcnt(0)
    s_barrier
    v_add_u32 v9, 133120, v2
    ds_write_b128 v9, a[192:195] offset:0
    ds_write_b128 v9, a[196:199] offset:1040
    ds_write_b128 v9, a[200:203] offset:2080
    ds_write_b128 v9, a[204:207] offset:3120
    ds_write_b128 v9, a[208:211] offset:4160
    ds_write_b128 v9, a[212:215] offset:5200
    ds_write_b128 v9, a[216:219] offset:6240
    ds_write_b128 v9, a[220:223] offset:7280
    ds_write_b128 v2, a[160:163] offset:8320
    ds_write_b128 v2, a[164:167] offset:9360
    ds_write_b128 v2, a[168:171] offset:10400
    ds_write_b128 v2, a[172:175] offset:11440
    ds_write_b128 v2, a[176:179] offset:12480
    ds_write_b128 v2, a[180:183] offset:13520
    ds_write_b128 v2, a[184:187] offset:14560
    ds_write_b128 v2, a[188:191] offset:15600
    s_call_b64 s[40:41], L_ldV
    s_add_u32 s57, s57, 8192
    s_add_u32 s58, s58, 8320
    s_cmp_eq_u32 s58, 74880
    s_cselect_b32 s58, 0, s58
    v_mov_b32 v196, -1
    v_mov_b32 v197, -1
    v_mov_b32 v198, -1
    v_mov_b32 v199, -1
    s_mul_i32 s46, s2, 24576
    s_add_u32 s46, s46, 26214400
    s_add_u32 s46, s46, s3
    buffer_store_dwordx4 v[196:199], v2, s[20:23], s46 offen offset:0 sc1
    buffer_store_dwordx4 v[196:199], v2, s[20:23], s46 offen offset:1024 sc1
    buffer_store_dwordx4 v[196:199], v2, s[20:23], s46 offen offset:2048 sc1
    buffer_store_dwordx4 v[196:199], v2, s[20:23], s46 offen offset:3072 sc1
    s_mul_i32 s46, s2, 24576
    s_add_u32 s46, s46, 26218496
    s_add_u32 s46, s46, s3
    buffer_store_dwordx4 v[196:199], v2, s[20:23], s46 offen offset:0 sc1
    buffer_store_dwordx4 v[196:199], v2, s[20:23], s46 offen offset:1024 sc1
    buffer_store_dwordx4 v[196:199], v2, s[20:23], s46 offen offset:2048 sc1
    buffer_store_dwordx4 v[196:199], v2, s[20:23], s46 offen offset:3072 sc1
    s_waitcnt lgkmcnt(0)
    s_barrier
    v_add_u32 v9, 141440, v2
    ds_write_b128 v9, v[112:115] offset:0
    ds_write_b128 v9, v[116:119] offset:1040
    ds_write_b128 v9, v[120:123] offset:2080
    ds_write_b128 v9, v[124:127] offset:3120
    ds_write_b128 v9, v[128:131] offset:4160
    ds_write_b128 v9, v[132:135] offset:5200
    ds_write_b128 v9, v[136:139] offset:6240
    ds_write_b128 v9, v[140:143] offset:7280
    ds_write_b128 v2, a[224:227] offset:16640
    ds_write_b128 v2, a[228:231] offset:17680
    ds_write_b128 v2, a[232:235] offset:18720
    ds_write_b128 v2, a[236:239] offset:19760
    ds_write_b128 v2, a[240:243] offset:20800
    ds_write_b128 v2, a[244:247] offset:21840
    ds_write_b128 v2, a[248:251] offset:22880
    ds_write_b128 v2, a[252:255] offset:23920
    s_call_b64 s[40:41], L_ldV
    s_add_u32 s57, s57, 8192
    s_add_u32 s58, s58, 8320
    s_cmp_eq_u32 s58, 74880
    s_cselect_b32 s58, 0, s58
    s_waitcnt vmcnt(55)
    s_call_b64 s[40:41], L_ldV
    s_waitcnt lgkmcnt(0)
    s_barrier
    s_waitcnt vmcnt(56)
    ds_write_b128 v2, v[144:147] offset:24960
    ds_write_b128 v2, v[148:151] offset:26000
    ds_write_b128 v2, v[152:155] offset:27040
    ds_write_b128 v2, v[156:159] offset:28080
    ds_write_b128 v2, v[160:163] offset:29120
    ds_write_b128 v2, v[164:167] offset:30160
    ds_write_b128 v2, v[168:171] offset:31200
    ds_write_b128 v2, v[172:175] offset:32240
    s_waitcnt vmcnt(55)
    s_call_b64 s[40:41], L_ldK
    s_add_u32 s59, s59, 8192
    s_add_u32 s60, s60, 8320
    s_cmp_eq_u32 s60, 149760
    s_cselect_b32 s60, 74880, s60
    s_add_u32 s57, s57, 8192
    s_add_u32 s58, s58, 8320
    s_cmp_eq_u32 s58, 74880
    s_cselect_b32 s58, 0, s58
    s_buffer_load_dword s100, s[32:35], 0
    s_mul_i32 s46, s2, 24576
    s_add_u32 s46, s46, 26222592
    s_add_u32 s46, s46, s3
    s_waitcnt vmcnt(62)
    buffer_store_dwordx4 v[196:199], v2, s[20:23], s46 offen offset:0 sc1
    s_waitcnt vmcnt(62)
    buffer_store_dwordx4 v[196:199], v2, s[20:23], s46 offen offset:1024 sc1
    s_waitcnt vmcnt(62)
    buffer_store_dwordx4 v[196:199], v2, s[20:23], s46 offen offset:2048 sc1
    s_waitcnt vmcnt(62)
    buffer_store_dwordx4 v[196:199], v2, s[20:23], s46 offen offset:3072 sc1
    s_mul_i32 s46, s2, 24576
    s_add_u32 s46, s46, 26226688
    s_add_u32 s46, s46, s3
    s_waitcnt vmcnt(62)
    buffer_store_dwordx4 v[196:199], v2, s[20:23], s46 offen offset:0 sc1
    s_waitcnt vmcnt(62)
    buffer_store_dwordx4 v[196:199], v2, s[20:23], s46 offen offset:1024 sc1
    s_waitcnt vmcnt(62)
    buffer_store_dwordx4 v[196:199], v2, s[20:23], s46 offen offset:2048 sc1
    s_waitcnt vmcnt(62)
    buffer_store_dwordx4 v[196:199], v2, s[20:23], s46 offen offset:3072 sc1
    s_waitcnt lgkmcnt(0)
    s_barrier
    s_waitcnt vmcnt(55)
    s_call_b64 s[40:41], L_ldV
    s_add_u32 s57, s57, 8192
    s_add_u32 s58, s58, 8320
    s_cmp_eq_u32 s58, 74880
    s_cselect_b32 s58, 0, s58
    s_cmp_lg_u32 s100, 0
    s_cbranch_scc1 L_nok
    v_mov_b32 v9, 0
    s_mov_b32 s47, 0
L_nsp:
    buffer_load_dword v10, v9, s[32:35], 0 offen sc1
    s_add_u32 s47, s47, 1
    s_waitcnt vmcnt(0)
    v_readfirstlane_b32 s100, v10
    s_cmp_gt_u32 s47, 20000
    s_cbranch_scc1 L_nok
    s_cmp_eq_u32 s100, 0
    s_cbranch_scc1 L_nsp
L_nok:
    v_mov_b32 v209, s100
    v_mov_b32 v10, 0
    ds_write_b32 v211, v209
    ds_write_b32 v211, v10 offset:4
    s_getreg_b32 s77, hwreg(HW_REG_XCC_ID, 0, 4)
    s_and_b32 s76, s2, 7
    s_lshl_b32 s76, s76, 8
    s_add_u32 s76, s76, 25186304
    s_and_b32 s46, s2, -8
    s_add_u32 s46, s46, s76
    v_mov_b32 v14, s100
    v_mov_b32 v15, s77
    s_waitcnt vmcnt(62)
    buffer_store_dwordx2 v[14:15], v11, s[20:23], s46 offen sc1
    s_mul_i32 s46, s2, 24576
    s_add_u32 s46, s46, 26230784
    s_add_u32 s46, s46, s3
    s_waitcnt vmcnt(62)
    buffer_store_dwordx4 v[196:199], v2, s[20:23], s46 offen offset:0 sc1
    s_waitcnt vmcnt(62)
    buffer_store_dwordx4 v[196:199], v2, s[20:23], s46 offen offset:1024 sc1
    s_waitcnt vmcnt(62)
    buffer_store_dwordx4 v[196:199], v2, s[20:23], s46 offen offset:2048 sc1
    s_waitcnt vmcnt(62)
    buffer_store_dwordx4 v[196:199], v2, s[20:23], s46 offen offset:3072 sc1
    s_mul_i32 s46, s2, 24576
    s_add_u32 s46, s46, 26234880
    s_add_u32 s46, s46, s3
    s_waitcnt vmcnt(62)
    buffer_store_dwordx4 v[196:199], v2, s[20:23], s46 offen offset:0 sc1
    s_waitcnt vmcnt(62)
    buffer_store_dwordx4 v[196:199], v2, s[20:23], s46 offen offset:1024 sc1
    s_waitcnt vmcnt(62)
    buffer_store_dwordx4 v[196:199], v2, s[20:23], s46 offen offset:2048 sc1
    s_waitcnt vmcnt(62)
    buffer_store_dwordx4 v[196:199], v2, s[20:23], s46 offen offset:3072 sc1
    s_waitcnt lgkmcnt(0)
    s_barrier
    s_waitcnt vmcnt(55)
    s_call_b64 s[40:41], L_ldV
    s_waitcnt lgkmcnt(0)
    s_barrier
    s_waitcnt vmcnt(55)
    s_call_b64 s[40:41], L_ldK
    s_add_u32 s59, s59, 8192
    s_add_u32 s60, s60, 8320
    s_cmp_eq_u32 s60, 149760
    s_cselect_b32 s60, 74880, s60
    s_add_u32 s57, s57, 8192
    s_add_u32 s58, s58, 8320
    s_cmp_eq_u32 s58, 74880
    s_cselect_b32 s58, 0, s58
    s_waitcnt lgkmcnt(0)
    s_barrier
    s_waitcnt vmcnt(55)
    s_call_b64 s[40:41], L_ldV
    s_add_u32 s57, s57, 8192
    s_add_u32 s58, s58, 8320
    s_cmp_eq_u32 s58, 74880
    s_cselect_b32 s58, 0, s58
    s_waitcnt vmcnt(55)
    s_call_b64 s[40:41], L_ldV
    v_and_b32 v9, 31, v1
    v_lshlrev_b32 v9, 3, v9
    s_waitcnt vmcnt(62)
    buffer_load_dwordx2 v[12:13], v9, s[20:23], s76 offen sc1
    s_waitcnt lgkmcnt(0)
    s_barrier
    s_waitcnt vmcnt(55)
    s_call_b64 s[40:41], L_ldK
    s_add_u32 s59, s59, 8192
    s_add_u32 s60, s60, 8320
    s_cmp_eq_u32 s60, 149760
    s_cselect_b32 s60, 74880, s60
    s_waitcnt lgkmcnt(0)
    s_barrier
    s_waitcnt vmcnt(55)
    s_call_b64 s[40:41], L_ldV
    s_waitcnt vmcnt(55)
    s_call_b64 s[40:41], L_ldK
    s_waitcnt lgkmcnt(0)
    s_barrier
    s_waitcnt vmcnt(55)
    s_call_b64 s[40:41], L_ldK
    s_waitcnt vmcnt(55)
    s_call_b64 s[40:41], L_ldV
    s_waitcnt lgkmcnt(0)
    s_barrier
    s_waitcnt vmcnt(55)
    s_call_b64 s[40:41], L_ldK
    s_waitcnt lgkmcnt(0)
    s_barrier
    s_waitcnt vmcnt(55)
    s_call_b64 s[40:41], L_ldV
    s_waitcnt vmcnt(55)
    s_call_b64 s[40:41], L_ldK
    s_waitcnt lgkmcnt(0)
    s_barrier
    s_waitcnt vmcnt(55)
    s_call_b64 s[40:41], L_ldV
    s_waitcnt lgkmcnt(0)
    s_barrier
    s_waitcnt vmcnt(55)
    s_call_b64 s[40:41], L_ldK
    s_waitcnt vmcnt(55)
    s_call_b64 s[40:41], L_ldV
    s_waitcnt lgkmcnt(0)
    s_barrier
    s_waitcnt vmcnt(55)
    s_call_b64 s[40:41], L_ldK
    v_cmp_eq_u64 vcc, v[12:13], v[14:15]
    s_nop 4
    s_cmp_eq_u64 vcc, -1
    s_cselect_b32 s77, 32, 0
    v_mov_b32 v16, s77
    ds_write_b32 v211, v16 offset:8
    s_waitcnt lgkmcnt(0)
    s_barrier
    s_waitcnt vmcnt(55)
    s_call_b64 s[40:41], L_ldV
    s_waitcnt vmcnt(55)
    s_call_b64 s[40:41], L_ldK
    s_waitcnt lgkmcnt(0)
    s_barrier
    s_cmp_eq_u32 s3, 0
    s_cselect_b32 s78, 0, 0xfff
    s_and_b32 s43, s2, -4
    s_lshl_b32 s43, s43, 9
    s_add_u32 s43, s43, 25198976
    s_mov_b32 s44, s64
    s_not_b32 s50, s100
    s_not_b32 s51, s100
    s_not_b32 s52, s100
    s_not_b32 s53, s100
    s_not_b32 s54, s100
    s_not_b32 s55, s100
    s_not_b32 s84, s100
    s_not_b32 s85, s100
    s_not_b32 s86, s100
    s_not_b32 s87, s100
    s_not_b32 s76, s100
    s_not_b32 s77, s100
    v_add_u32 v4, s61, v2
    v_add_u32 v5, s61, v3
    v_add_u32 v7, 0x20000, v4
    v_add_u32 v8, 0x20000, v5
    s_waitcnt lgkmcnt(0)
    s_barrier
    s_waitcnt vmcnt(55)
    s_call_b64 s[40:41], L_ldV
    s_waitcnt lgkmcnt(0)
    s_barrier
    s_waitcnt vmcnt(55)
    s_call_b64 s[40:41], L_ldK
    s_waitcnt vmcnt(55)
    s_call_b64 s[40:41], L_ldV
    s_waitcnt lgkmcnt(0)
    s_barrier
    s_waitcnt vmcnt(55)
    s_call_b64 s[40:41], L_ldK
    s_waitcnt lgkmcnt(0)
    s_barrier
    s_waitcnt vmcnt(55)
    s_call_b64 s[40:41], L_ldV
    s_waitcnt vmcnt(55)
    s_call_b64 s[40:41], L_ldK
    s_waitcnt lgkmcnt(0)
    s_barrier
    s_waitcnt vmcnt(55)
    s_call_b64 s[40:41], L_ldV
    s_waitcnt lgkmcnt(0)
    s_barrier
    s_cmp_eq_u32 s78, 0xfff
    s_cbranch_scc1 L_gp23
    s_getreg_b32 s47, hwreg(HW_REG_IB_STS, 8, 4)
    s_buffer_load_dword s50, s[20:23], s80 offset:0 glc
    s_buffer_load_dword s51, s[20:23], s80 offset:4096 glc
    s_buffer_load_dword s52, s[20:23], s80 offset:8192 glc
    s_buffer_load_dword s53, s[20:23], s80 offset:12288 glc
    s_buffer_load_dword s54, s[20:23], s80 offset:16384 glc
    s_buffer_load_dword s55, s[20:23], s80 offset:20480 glc
    s_buffer_load_dword s84, s[20:23], s80 offset:24576 glc
    s_buffer_load_dword s85, s[20:23], s80 offset:28672 glc
    s_buffer_load_dword s86, s[20:23], s43 offset:0 glc
    s_buffer_load_dword s87, s[20:23], s43 offset:512 glc
    s_buffer_load_dword s76, s[20:23], s43 offset:1024 glc
    s_buffer_load_dword s77, s[20:23], s43 offset:1536 glc
L_gp23:
    s_waitcnt vmcnt(55)
    s_call_b64 s[40:41], L_ldK
    s_waitcnt vmcnt(55)
    s_call_b64 s[40:41], L_ldV
    s_barrier
    s_cmp_eq_u32 s78, 0xfff
    s_cbranch_scc1 L_gp24
    s_getreg_b32 s47, hwreg(HW_REG_IB_STS, 8, 4)
    s_cmp_eq_u32 s50, s100
    s_cselect_b32 s46, 1, 0
    s_or_b32 s78, s78, s46
    s_cmp_eq_u32 s51, s100
    s_cselect_b32 s46, 2, 0
    s_or_b32 s78, s78, s46
    s_cmp_eq_u32 s52, s100
    s_cselect_b32 s46, 4, 0
    s_or_b32 s78, s78, s46
    s_cmp_eq_u32 s53, s100
    s_cselect_b32 s46, 8, 0
    s_or_b32 s78, s78, s46
    s_cmp_eq_u32 s54, s100
    s_cselect_b32 s46, 16, 0
    s_or_b32 s78, s78, s46
    s_cmp_eq_u32 s55, s100
    s_cselect_b32 s46, 32, 0
    s_or_b32 s78, s78, s46
    s_cmp_eq_u32 s84, s100
    s_cselect_b32 s46, 64, 0
    s_or_b32 s78, s78, s46
    s_cmp_eq_u32 s85, s100
    s_cselect_b32 s46, 128, 0
    s_or_b32 s78, s78, s46
    s_cmp_eq_u32 s86, s100
    s_cselect_b32 s46, 256, 0
    s_or_b32 s78, s78, s46
    s_cmp_eq_u32 s87, s100
    s_cselect_b32 s46, 512, 0
    s_or_b32 s78, s78, s46
    s_cmp_eq_u32 s76, s100
    s_cselect_b32 s46, 1024, 0
    s_or_b32 s78, s78, s46
    s_cmp_eq_u32 s77, s100
    s_cselect_b32 s46, 2048, 0
    s_or_b32 s78, s78, s46
    s_cmp_lg_u32 s47, 0
    s_cbranch_scc1 L_gp24
    s_cmp_eq_u32 s78, 0xfff
    s_cbranch_scc1 L_gp24
    s_buffer_load_dword s50, s[20:23], s80 offset:0 glc
    s_buffer_load_dword s51, s[20:23], s80 offset:4096 glc
    s_buffer_load_dword s52, s[20:23], s80 offset:8192 glc
    s_buffer_load_dword s53, s[20:23], s80 offset:12288 glc
    s_buffer_load_dword s54, s[20:23], s80 offset:16384 glc
    s_buffer_load_dword s55, s[20:23], s80 offset:20480 glc
    s_buffer_load_dword s84, s[20:23], s80 offset:24576 glc
    s_buffer_load_dword s85, s[20:23], s80 offset:28672 glc
    s_buffer_load_dword s86, s[20:23], s43 offset:0 glc
    s_buffer_load_dword s87, s[20:23], s43 offset:512 glc
    s_buffer_load_dword s76, s[20:23], s43 offset:1024 glc
    s_buffer_load_dword s77, s[20:23], s43 offset:1536 glc
L_gp24:
    s_waitcnt vmcnt(55)
    s_call_b64 s[40:41], L_ldK
    s_waitcnt vmcnt(56)
    s_barrier
    s_cmp_eq_u32 s78, 0xfff
    s_cbranch_scc1 L_gp25
    s_getreg_b32 s47, hwreg(HW_REG_IB_STS, 8, 4)
    s_cmp_eq_u32 s50, s100
    s_cselect_b32 s46, 1, 0
    s_or_b32 s78, s78, s46
    s_cmp_eq_u32 s51, s100
    s_cselect_b32 s46, 2, 0
    s_or_b32 s78, s78, s46
    s_cmp_eq_u32 s52, s100
    s_cselect_b32 s46, 4, 0
    s_or_b32 s78, s78, s46
    s_cmp_eq_u32 s53, s100
    s_cselect_b32 s46, 8, 0
    s_or_b32 s78, s78, s46
    s_cmp_eq_u32 s54, s100
    s_cselect_b32 s46, 16, 0
    s_or_b32 s78, s78, s46
    s_cmp_eq_u32 s55, s100
    s_cselect_b32 s46, 32, 0
    s_or_b32 s78, s78, s46
    s_cmp_eq_u32 s84, s100
    s_cselect_b32 s46, 64, 0
    s_or_b32 s78, s78, s46
    s_cmp_eq_u32 s85, s100
    s_cselect_b32 s46, 128, 0
    s_or_b32 s78, s78, s46
    s_cmp_eq_u32 s86, s100
    s_cselect_b32 s46, 256, 0
    s_or_b32 s78, s78, s46
    s_cmp_eq_u32 s87, s100
    s_cselect_b32 s46, 512, 0
    s_or_b32 s78, s78, s46
    s_cmp_eq_u32 s76, s100
    s_cselect_b32 s46, 1024, 0
    s_or_b32 s78, s78, s46
    s_cmp_eq_u32 s77, s100
    s_cselect_b32 s46, 2048, 0
    s_or_b32 s78, s78, s46
    s_cmp_lg_u32 s47, 0
    s_cbranch_scc1 L_gp25
    s_cmp_eq_u32 s78, 0xfff
    s_cbranch_scc1 L_gp25
    s_buffer_load_dword s50, s[20:23], s80 offset:0 glc
    s_buffer_load_dword s51, s[20:23], s80 offset:4096 glc
    s_buffer_load_dword s52, s[20:23], s80 offset:8192 glc
    s_buffer_load_dword s53, s[20:23], s80 offset:12288 glc
    s_buffer_load_dword s54, s[20:23], s80 offset:16384 glc
    s_buffer_load_dword s55, s[20:23], s80 offset:20480 glc
    s_buffer_load_dword s84, s[20:23], s80 offset:24576 glc
    s_buffer_load_dword s85, s[20:23], s80 offset:28672 glc
    s_buffer_load_dword s86, s[20:23], s43 offset:0 glc
    s_buffer_load_dword s87, s[20:23], s43 offset:512 glc
    s_buffer_load_dword s76, s[20:23], s43 offset:1024 glc
    s_buffer_load_dword s77, s[20:23], s43 offset:1536 glc
L_gp25:
    s_waitcnt vmcnt(55)
    s_call_b64 s[40:41], L_ldV
    s_waitcnt vmcnt(55)
    s_call_b64 s[40:41], L_ldK
    s_waitcnt vmcnt(56)
    s_barrier
    s_cmp_eq_u32 s78, 0xfff
    s_cbranch_scc1 L_gp26
    s_getreg_b32 s47, hwreg(HW_REG_IB_STS, 8, 4)
    s_cmp_eq_u32 s50, s100
    s_cselect_b32 s46, 1, 0
    s_or_b32 s78, s78, s46
    s_cmp_eq_u32 s51, s100
    s_cselect_b32 s46, 2, 0
    s_or_b32 s78, s78, s46
    s_cmp_eq_u32 s52, s100
    s_cselect_b32 s46, 4, 0
    s_or_b32 s78, s78, s46
    s_cmp_eq_u32 s53, s100
    s_cselect_b32 s46, 8, 0
    s_or_b32 s78, s78, s46
    s_cmp_eq_u32 s54, s100
    s_cselect_b32 s46, 16, 0
    s_or_b32 s78, s78, s46
    s_cmp_eq_u32 s55, s100
    s_cselect_b32 s46, 32, 0
    s_or_b32 s78, s78, s46
    s_cmp_eq_u32 s84, s100
    s_cselect_b32 s46, 64, 0
    s_or_b32 s78, s78, s46
    s_cmp_eq_u32 s85, s100
    s_cselect_b32 s46, 128, 0
    s_or_b32 s78, s78, s46
    s_cmp_eq_u32 s86, s100
    s_cselect_b32 s46, 256, 0
    s_or_b32 s78, s78, s46
    s_cmp_eq_u32 s87, s100
    s_cselect_b32 s46, 512, 0
    s_or_b32 s78, s78, s46
    s_cmp_eq_u32 s76, s100
    s_cselect_b32 s46, 1024, 0
    s_or_b32 s78, s78, s46
    s_cmp_eq_u32 s77, s100
    s_cselect_b32 s46, 2048, 0
    s_or_b32 s78, s78, s46
    s_cmp_lg_u32 s47, 0
    s_cbranch_scc1 L_gp26
    s_cmp_eq_u32 s78, 0xfff
    s_cbranch_scc1 L_gp26
    s_buffer_load_dword s50, s[20:23], s80 offset:0 glc
    s_buffer_load_dword s51, s[20:23], s80 offset:4096 glc
    s_buffer_load_dword s52, s[20:23], s80 offset:8192 glc
    s_buffer_load_dword s53, s[20:23], s80 offset:12288 glc
    s_buffer_load_dword s54, s[20:23], s80 offset:16384 glc
    s_buffer_load_dword s55, s[20:23], s80 offset:20480 glc
    s_buffer_load_dword s84, s[20:23], s80 offset:24576 glc
    s_buffer_load_dword s85, s[20:23], s80 offset:28672 glc
    s_buffer_load_dword s86, s[20:23], s43 offset:0 glc
    s_buffer_load_dword s87, s[20:23], s43 offset:512 glc
    s_buffer_load_dword s76, s[20:23], s43 offset:1024 glc
    s_buffer_load_dword s77, s[20:23], s43 offset:1536 glc
L_gp26:
    s_waitcnt vmcnt(55)
    s_call_b64 s[40:41], L_ldV
    s_waitcnt vmcnt(48)
    s_barrier
    s_cmp_eq_u32 s78, 0xfff
    s_cbranch_scc1 L_gp27
    s_getreg_b32 s47, hwreg(HW_REG_IB_STS, 8, 4)
    s_cmp_eq_u32 s50, s100
    s_cselect_b32 s46, 1, 0
    s_or_b32 s78, s78, s46
    s_cmp_eq_u32 s51, s100
    s_cselect_b32 s46, 2, 0
    s_or_b32 s78, s78, s46
    s_cmp_eq_u32 s52, s100
    s_cselect_b32 s46, 4, 0
    s_or_b32 s78, s78, s46
    s_cmp_eq_u32 s53, s100
    s_cselect_b32 s46, 8, 0
    s_or_b32 s78, s78, s46
    s_cmp_eq_u32 s54, s100
    s_cselect_b32 s46, 16, 0
    s_or_b32 s78, s78, s46
    s_cmp_eq_u32 s55, s100
    s_cselect_b32 s46, 32, 0
    s_or_b32 s78, s78, s46
    s_cmp_eq_u32 s84, s100
    s_cselect_b32 s46, 64, 0
    s_or_b32 s78, s78, s46
    s_cmp_eq_u32 s85, s100
    s_cselect_b32 s46, 128, 0
    s_or_b32 s78, s78, s46
    s_cmp_eq_u32 s86, s100
    s_cselect_b32 s46, 256, 0
    s_or_b32 s78, s78, s46
    s_cmp_eq_u32 s87, s100
    s_cselect_b32 s46, 512, 0
    s_or_b32 s78, s78, s46
    s_cmp_eq_u32 s76, s100
    s_cselect_b32 s46, 1024, 0
    s_or_b32 s78, s78, s46
    s_cmp_eq_u32 s77, s100
    s_cselect_b32 s46, 2048, 0
    s_or_b32 s78, s78, s46
    s_cmp_lg_u32 s47, 0
    s_cbranch_scc1 L_gp27
    s_cmp_eq_u32 s78, 0xfff
    s_cbranch_scc1 L_gp27
    s_buffer_load_dword s50, s[20:23], s80 offset:0 glc
    s_buffer_load_dword s51, s[20:23], s80 offset:4096 glc
    s_buffer_load_dword s52, s[20:23], s80 offset:8192 glc
    s_buffer_load_dword s53, s[20:23], s80 offset:12288 glc
    s_buffer_load_dword s54, s[20:23], s80 offset:16384 glc
    s_buffer_load_dword s55, s[20:23], s80 offset:20480 glc
    s_buffer_load_dword s84, s[20:23], s80 offset:24576 glc
    s_buffer_load_dword s85, s[20:23], s80 offset:28672 glc
    s_buffer_load_dword s86, s[20:23], s43 offset:0 glc
    s_buffer_load_dword s87, s[20:23], s43 offset:512 glc
    s_buffer_load_dword s76, s[20:23], s43 offset:1024 glc
    s_buffer_load_dword s77, s[20:23], s43 offset:1536 glc
L_gp27:
    s_call_b64 s[40:41], L_ldK
    s_waitcnt vmcnt(55)
    s_call_b64 s[40:41], L_ldV
    s_waitcnt vmcnt(48)
    s_barrier
    s_cmp_eq_u32 s78, 0xfff
    s_cbranch_scc1 L_gp28
    s_getreg_b32 s47, hwreg(HW_REG_IB_STS, 8, 4)
    s_cmp_eq_u32 s50, s100
    s_cselect_b32 s46, 1, 0
    s_or_b32 s78, s78, s46
    s_cmp_eq_u32 s51, s100
    s_cselect_b32 s46, 2, 0
    s_or_b32 s78, s78, s46
    s_cmp_eq_u32 s52, s100
    s_cselect_b32 s46, 4, 0
    s_or_b32 s78, s78, s46
    s_cmp_eq_u32 s53, s100
    s_cselect_b32 s46, 8, 0
    s_or_b32 s78, s78, s46
    s_cmp_eq_u32 s54, s100
    s_cselect_b32 s46, 16, 0
    s_or_b32 s78, s78, s46
    s_cmp_eq_u32 s55, s100
    s_cselect_b32 s46, 32, 0
    s_or_b32 s78, s78, s46
    s_cmp_eq_u32 s84, s100
    s_cselect_b32 s46, 64, 0
    s_or_b32 s78, s78, s46
    s_cmp_eq_u32 s85, s100
    s_cselect_b32 s46, 128, 0
    s_or_b32 s78, s78, s46
    s_cmp_eq_u32 s86, s100
    s_cselect_b32 s46, 256, 0
    s_or_b32 s78, s78, s46
    s_cmp_eq_u32 s87, s100
    s_cselect_b32 s46, 512, 0
    s_or_b32 s78, s78, s46
    s_cmp_eq_u32 s76, s100
    s_cselect_b32 s46, 1024, 0
    s_or_b32 s78, s78, s46
    s_cmp_eq_u32 s77, s100
    s_cselect_b32 s46, 2048, 0
    s_or_b32 s78, s78, s46
    s_cmp_lg_u32 s47, 0
    s_cbranch_scc1 L_gp28
    s_cmp_eq_u32 s78, 0xfff
    s_cbranch_scc1 L_gp28
    s_buffer_load_dword s50, s[20:23], s80 offset:0 glc
    s_buffer_load_dword s51, s[20:23], s80 offset:4096 glc
    s_buffer_load_dword s52, s[20:23], s80 offset:8192 glc
    s_buffer_load_dword s53, s[20:23], s80 offset:12288 glc
    s_buffer_load_dword s54, s[20:23], s80 offset:16384 glc
    s_buffer_load_dword s55, s[20:23], s80 offset:20480 glc
    s_buffer_load_dword s84, s[20:23], s80 offset:24576 glc
    s_buffer_load_dword s85, s[20:23], s80 offset:28672 glc
    s_buffer_load_dword s86, s[20:23], s43 offset:0 glc
    s_buffer_load_dword s87, s[20:23], s43 offset:512 glc
    s_buffer_load_dword s76, s[20:23], s43 offset:1024 glc
    s_buffer_load_dword s77, s[20:23], s43 offset:1536 glc
L_gp28:
    s_call_b64 s[40:41], L_ldV
    s_waitcnt vmcnt(40)
    s_barrier
    s_cmp_eq_u32 s78, 0xfff
    s_cbranch_scc1 L_gp29
    s_getreg_b32 s47, hwreg(HW_REG_IB_STS, 8, 4)
    s_cmp_eq_u32 s50, s100
    s_cselect_b32 s46, 1, 0
    s_or_b32 s78, s78, s46
    s_cmp_eq_u32 s51, s100
    s_cselect_b32 s46, 2, 0
    s_or_b32 s78, s78, s46
    s_cmp_eq_u32 s52, s100
    s_cselect_b32 s46, 4, 0
    s_or_b32 s78, s78, s46
    s_cmp_eq_u32 s53, s100
    s_cselect_b32 s46, 8, 0
    s_or_b32 s78, s78, s46
    s_cmp_eq_u32 s54, s100
    s_cselect_b32 s46, 16, 0
    s_or_b32 s78, s78, s46
    s_cmp_eq_u32 s55, s100
    s_cselect_b32 s46, 32, 0
    s_or_b32 s78, s78, s46
    s_cmp_eq_u32 s84, s100
    s_cselect_b32 s46, 64, 0
    s_or_b32 s78, s78, s46
    s_cmp_eq_u32 s85, s100
    s_cselect_b32 s46, 128, 0
    s_or_b32 s78, s78, s46
    s_cmp_eq_u32 s86, s100
    s_cselect_b32 s46, 256, 0
    s_or_b32 s78, s78, s46
    s_cmp_eq_u32 s87, s100
    s_cselect_b32 s46, 512, 0
    s_or_b32 s78, s78, s46
    s_cmp_eq_u32 s76, s100
    s_cselect_b32 s46, 1024, 0
    s_or_b32 s78, s78, s46
    s_cmp_eq_u32 s77, s100
    s_cselect_b32 s46, 2048, 0
    s_or_b32 s78, s78, s46
    s_cmp_lg_u32 s47, 0
    s_cbranch_scc1 L_gp29
    s_cmp_eq_u32 s78, 0xfff
    s_cbranch_scc1 L_gp29
    s_buffer_load_dword s50, s[20:23], s80 offset:0 glc
    s_buffer_load_dword s51, s[20:23], s80 offset:4096 glc
    s_buffer_load_dword s52, s[20:23], s80 offset:8192 glc
    s_buffer_load_dword s53, s[20:23], s80 offset:12288 glc
    s_buffer_load_dword s54, s[20:23], s80 offset:16384 glc
    s_buffer_load_dword s55, s[20:23], s80 offset:20480 glc
    s_buffer_load_dword s84, s[20:23], s80 offset:24576 glc
    s_buffer_load_dword s85, s[20:23], s80 offset:28672 glc
    s_buffer_load_dword s86, s[20:23], s43 offset:0 glc
    s_buffer_load_dword s87, s[20:23], s43 offset:512 glc
    s_buffer_load_dword s76, s[20:23], s43 offset:1024 glc
    s_buffer_load_dword s77, s[20:23], s43 offset:1536 glc
L_gp29:
    s_call_b64 s[40:41], L_ldV
    s_waitcnt vmcnt(32)
    s_barrier
    s_cmp_eq_u32 s78, 0xfff
    s_cbranch_scc1 L_gp30
    s_getreg_b32 s47, hwreg(HW_REG_IB_STS, 8, 4)
    s_cmp_eq_u32 s50, s100
    s_cselect_b32 s46, 1, 0
    s_or_b32 s78, s78, s46
    s_cmp_eq_u32 s51, s100
    s_cselect_b32 s46, 2, 0
    s_or_b32 s78, s78, s46
    s_cmp_eq_u32 s52, s100
    s_cselect_b32 s46, 4, 0
    s_or_b32 s78, s78, s46
    s_cmp_eq_u32 s53, s100
    s_cselect_b32 s46, 8, 0
    s_or_b32 s78, s78, s46
    s_cmp_eq_u32 s54, s100
    s_cselect_b32 s46, 16, 0
    s_or_b32 s78, s78, s46
    s_cmp_eq_u32 s55, s100
    s_cselect_b32 s46, 32, 0
    s_or_b32 s78, s78, s46
    s_cmp_eq_u32 s84, s100
    s_cselect_b32 s46, 64, 0
    s_or_b32 s78, s78, s46
    s_cmp_eq_u32 s85, s100
    s_cselect_b32 s46, 128, 0
    s_or_b32 s78, s78, s46
    s_cmp_eq_u32 s86, s100
    s_cselect_b32 s46, 256, 0
    s_or_b32 s78, s78, s46
    s_cmp_eq_u32 s87, s100
    s_cselect_b32 s46, 512, 0
    s_or_b32 s78, s78, s46
    s_cmp_eq_u32 s76, s100
    s_cselect_b32 s46, 1024, 0
    s_or_b32 s78, s78, s46
    s_cmp_eq_u32 s77, s100
    s_cselect_b32 s46, 2048, 0
    s_or_b32 s78, s78, s46
    s_cmp_lg_u32 s47, 0
    s_cbranch_scc1 L_gp30
    s_cmp_eq_u32 s78, 0xfff
    s_cbranch_scc1 L_gp30
    s_buffer_load_dword s50, s[20:23], s80 offset:0 glc
    s_buffer_load_dword s51, s[20:23], s80 offset:4096 glc
    s_buffer_load_dword s52, s[20:23], s80 offset:8192 glc
    s_buffer_load_dword s53, s[20:23], s80 offset:12288 glc
    s_buffer_load_dword s54, s[20:23], s80 offset:16384 glc
    s_buffer_load_dword s55, s[20:23], s80 offset:20480 glc
    s_buffer_load_dword s84, s[20:23], s80 offset:24576 glc
    s_buffer_load_dword s85, s[20:23], s80 offset:28672 glc
    s_buffer_load_dword s86, s[20:23], s43 offset:0 glc
    s_buffer_load_dword s87, s[20:23], s43 offset:512 glc
    s_buffer_load_dword s76, s[20:23], s43 offset:1024 glc
    s_buffer_load_dword s77, s[20:23], s43 offset:1536 glc
L_gp30:
    s_call_b64 s[40:41], L_ldV
    s_waitcnt vmcnt(24)
    s_barrier
    s_cmp_eq_u32 s78, 0xfff
    s_cbranch_scc1 L_gp31
    s_getreg_b32 s47, hwreg(HW_REG_IB_STS, 8, 4)
    s_cmp_eq_u32 s50, s100
    s_cselect_b32 s46, 1, 0
    s_or_b32 s78, s78, s46
    s_cmp_eq_u32 s51, s100
    s_cselect_b32 s46, 2, 0
    s_or_b32 s78, s78, s46
    s_cmp_eq_u32 s52, s100
    s_cselect_b32 s46, 4, 0
    s_or_b32 s78, s78, s46
    s_cmp_eq_u32 s53, s100
    s_cselect_b32 s46, 8, 0
    s_or_b32 s78, s78, s46
    s_cmp_eq_u32 s54, s100
    s_cselect_b32 s46, 16, 0
    s_or_b32 s78, s78, s46
    s_cmp_eq_u32 s55, s100
    s_cselect_b32 s46, 32, 0
    s_or_b32 s78, s78, s46
    s_cmp_eq_u32 s84, s100
    s_cselect_b32 s46, 64, 0
    s_or_b32 s78, s78, s46
    s_cmp_eq_u32 s85, s100
    s_cselect_b32 s46, 128, 0
    s_or_b32 s78, s78, s46
    s_cmp_eq_u32 s86, s100
    s_cselect_b32 s46, 256, 0
    s_or_b32 s78, s78, s46
    s_cmp_eq_u32 s87, s100
    s_cselect_b32 s46, 512, 0
    s_or_b32 s78, s78, s46
    s_cmp_eq_u32 s76, s100
    s_cselect_b32 s46, 1024, 0
    s_or_b32 s78, s78, s46
    s_cmp_eq_u32 s77, s100
    s_cselect_b32 s46, 2048, 0
    s_or_b32 s78, s78, s46
    s_cmp_lg_u32 s47, 0
    s_cbranch_scc1 L_gp31
    s_cmp_eq_u32 s78, 0xfff
    s_cbranch_scc1 L_gp31
    s_buffer_load_dword s50, s[20:23], s80 offset:0 glc
    s_buffer_load_dword s51, s[20:23], s80 offset:4096 glc
    s_buffer_load_dword s52, s[20:23], s80 offset:8192 glc
    s_buffer_load_dword s53, s[20:23], s80 offset:12288 glc
    s_buffer_load_dword s54, s[20:23], s80 offset:16384 glc
    s_buffer_load_dword s55, s[20:23], s80 offset:20480 glc
    s_buffer_load_dword s84, s[20:23], s80 offset:24576 glc
    s_buffer_load_dword s85, s[20:23], s80 offset:28672 glc
    s_buffer_load_dword s86, s[20:23], s43 offset:0 glc
    s_buffer_load_dword s87, s[20:23], s43 offset:512 glc
    s_buffer_load_dword s76, s[20:23], s43 offset:1024 glc
    s_buffer_load_dword s77, s[20:23], s43 offset:1536 glc
L_gp31:
    s_mov_b32 m0, 149760
    s_call_b64 s[40:41], L_ldW
    s_waitcnt vmcnt(24)
    s_cmp_eq_u32 s78, 0xfff
    s_cbranch_scc0 L_fw
L_fwr:
    s_barrier
    s_mov_b32 m0, 24960
    s_call_b64 s[40:41], L_ldW
    s_mov_b32 m0, 33280
    s_call_b64 s[40:41], L_ldW
    s_mov_b32 m0, 41600
    s_call_b64 s[40:41], L_ldW
    s_waitcnt vmcnt(40)
    s_barrier
    s_mov_b32 m0, 49920
    s_call_b64 s[40:41], L_ldW
    s_mov_b32 m0, 99840
    s_call_b64 s[40:41], L_ldW
    s_waitcnt vmcnt(55)
    s_mov_b32 m0, 58240
    s_call_b64 s[40:41], L_ldW
    s_waitcnt vmcnt(56)
    s_barrier
    s_waitcnt vmcnt(54)
    s_waitcnt lgkmcnt(0)
    s_branch L_t1
L_fw:
    s_mov_b32 s47, 0
L_fw0:
    s_waitcnt lgkmcnt(0)
    s_cmp_eq_u32 s50, s100
    s_cselect_b32 s46, 1, 0
    s_or_b32 s78, s78, s46
    s_cmp_eq_u32 s51, s100
    s_cselect_b32 s46, 2, 0
    s_or_b32 s78, s78, s46
    s_cmp_eq_u32 s52, s100
    s_cselect_b32 s46, 4, 0
    s_or_b32 s78, s78, s46
    s_cmp_eq_u32 s53, s100
    s_cselect_b32 s46, 8, 0
    s_or_b32 s78, s78, s46
    s_cmp_eq_u32 s54, s100
    s_cselect_b32 s46, 16, 0
    s_or_b32 s78, s78, s46
    s_cmp_eq_u32 s55, s100
    s_cselect_b32 s46, 32, 0
    s_or_b32 s78, s78, s46
    s_cmp_eq_u32 s84, s100
    s_cselect_b32 s46, 64, 0
    s_or_b32 s78, s78, s46
    s_cmp_eq_u32 s85, s100
    s_cselect_b32 s46, 128, 0
    s_or_b32 s78, s78, s46
    s_cmp_eq_u32 s86, s100
    s_cselect_b32 s46, 256, 0
    s_or_b32 s78, s78, s46
    s_cmp_eq_u32 s87, s100
    s_cselect_b32 s46, 512, 0
    s_or_b32 s78, s78, s46
    s_cmp_eq_u32 s76, s100
    s_cselect_b32 s46, 1024, 0
    s_or_b32 s78, s78, s46
    s_cmp_eq_u32 s77, s100
    s_cselect_b32 s46, 2048, 0
    s_or_b32 s78, s78, s46
    s_cmp_eq_u32 s78, 0xfff
    s_cbranch_scc1 L_fwr
    s_buffer_load_dword s50, s[20:23], s80 offset:0 glc
    s_buffer_load_dword s51, s[20:23], s80 offset:4096 glc
    s_buffer_load_dword s52, s[20:23], s80 offset:8192 glc
    s_buffer_load_dword s53, s[20:23], s80 offset:12288 glc
    s_buffer_load_dword s54, s[20:23], s80 offset:16384 glc
    s_buffer_load_dword s55, s[20:23], s80 offset:20480 glc
    s_buffer_load_dword s84, s[20:23], s80 offset:24576 glc
    s_buffer_load_dword s85, s[20:23], s80 offset:28672 glc
    s_buffer_load_dword s86, s[20:23], s43 offset:0 glc
    s_buffer_load_dword s87, s[20:23], s43 offset:512 glc
    s_buffer_load_dword s76, s[20:23], s43 offset:1024 glc
    s_buffer_load_dword s77, s[20:23], s43 offset:1536 glc
    s_add_u32 s47, s47, 1
    s_cmp_le_u32 s47, 20000
    s_cbranch_scc1 L_fw0
    s_waitcnt lgkmcnt(0)
    s_branch L_fwr
L_rarea:
    s_call_b64 s[40:41], L_rsc1
    s_branch L_rarea_ret
L_rareb:
    s_call_b64 s[40:41], L_rsc0
    s_branch L_rareb_ret
L_rarec:
    s_call_b64 s[40:41], L_rsc1
    s_branch L_rarec_ret
L_rareh0:
    s_call_b64 s[40:41], L_rsc1
    s_branch L_rareh0_ret
L_rareh1:
    s_call_b64 s[40:41], L_rsc1
    s_branch L_rareh1_ret
L_rareh2:
    s_call_b64 s[40:41], L_rsc1
    s_branch L_rareh2_ret
L_rsc0:
    s_nop 15
    v_mov_b32 v198, v197
    s_nop 1
    v_permlane32_swap_b32 v198, v197
    v_max3_f32 v197, v198, v197, 0
    v_exp_f32 v199, -v197
    v_sub_f32 v80, v80, v197
    v_sub_f32 v81, v81, v197
    v_sub_f32 v82, v82, v197
    v_sub_f32 v83, v83, v197
    v_sub_f32 v84, v84, v197
    v_sub_f32 v85, v85, v197
    v_sub_f32 v86, v86, v197
    v_sub_f32 v87, v87, v197
    v_sub_f32 v88, v88, v197
    v_sub_f32 v89, v89, v197
    v_sub_f32 v90, v90, v197
    v_sub_f32 v91, v91, v197
    v_sub_f32 v92, v92, v197
    v_sub_f32 v93, v93, v197
    v_sub_f32 v94, v94, v197
    v_sub_f32 v95, v95, v197
    v_sub_f32 v112, v112, v197
    v_sub_f32 v113, v113, v197
    v_sub_f32 v114, v114, v197
    v_sub_f32 v115, v115, v197
    v_sub_f32 v116, v116, v197
    v_sub_f32 v117, v117, v197
    v_sub_f32 v118, v118, v197
    v_sub_f32 v119, v119, v197
    v_sub_f32 v120, v120, v197
    v_sub_f32 v121, v121, v197
    v_sub_f32 v122, v122, v197
    v_sub_f32 v123, v123, v197
    v_sub_f32 v124, v124, v197
    v_sub_f32 v125, v125, v197
    v_sub_f32 v126, v126, v197
    v_sub_f32 v127, v127, v197
    v_mul_f32 v196, v199, v196
    v_mul_f32 v16, v199, v16
    v_mul_f32 v17, v199, v17
    v_mul_f32 v18, v199, v18
    v_mul_f32 v19, v199, v19
    v_mul_f32 v20, v199, v20
    v_mul_f32 v21, v199, v21
    v_mul_f32 v22, v199, v22
    v_mul_f32 v23, v199, v23
    v_mul_f32 v24, v199, v24
    v_mul_f32 v25, v199, v25
    v_mul_f32 v26, v199, v26
    v_mul_f32 v27, v199, v27
    v_mul_f32 v28, v199, v28
    v_mul_f32 v29, v199, v29
    v_mul_f32 v30, v199, v30
    v_mul_f32 v31, v199, v31
    v_mul_f32 v32, v199, v32
    v_mul_f32 v33, v199, v33
    v_mul_f32 v34, v199, v34
    v_mul_f32 v35, v199, v35
    v_mul_f32 v36, v199, v36
    v_mul_f32 v37, v199, v37
    v_mul_f32 v38, v199, v38
    v_mul_f32 v39, v199, v39
    v_mul_f32 v40, v199, v40
    v_mul_f32 v41, v199, v41
    v_mul_f32 v42, v199, v42
    v_mul_f32 v43, v199, v43
    v_mul_f32 v44, v199, v44
    v_mul_f32 v45, v199, v45
    v_mul_f32 v46, v199, v46
    v_mul_f32 v47, v199, v47
    v_mul_f32 v48, v199, v48
    v_mul_f32 v49, v199, v49
    v_mul_f32 v50, v199, v50
    v_mul_f32 v51, v199, v51
    v_mul_f32 v52, v199, v52
    v_mul_f32 v53, v199, v53
    v_mul_f32 v54, v199, v54
    v_mul_f32 v55, v199, v55
    v_mul_f32 v56, v199, v56
    v_mul_f32 v57, v199, v57
    v_mul_f32 v58, v199, v58
    v_mul_f32 v59, v199, v59
    v_mul_f32 v60, v199, v60
    v_mul_f32 v61, v199, v61
    v_mul_f32 v62, v199, v62
    v_mul_f32 v63, v199, v63
    v_mul_f32 v64, v199, v64
    v_mul_f32 v65, v199, v65
    v_mul_f32 v66, v199, v66
    v_mul_f32 v67, v199, v67
    v_mul_f32 v68, v199, v68
    v_mul_f32 v69, v199, v69
    v_mul_f32 v70, v199, v70
    v_mul_f32 v71, v199, v71
    v_mul_f32 v72, v199, v72
    v_mul_f32 v73, v199, v73
    v_mul_f32 v74, v199, v74
    v_mul_f32 v75, v199, v75
    v_mul_f32 v76, v199, v76
    v_mul_f32 v77, v199, v77
    v_mul_f32 v78, v199, v78
    v_mul_f32 v79, v199, v79
    v_lshlrev_b32 v200, 16, v136
    v_and_b32 v201, 0xffff0000, v136
    v_mul_f32 v200, v199, v200
    v_mul_f32 v201, v199, v201
    v_cvt_pk_bf16_f32 v136, v200, v201
    v_lshlrev_b32 v200, 16, v137
    v_and_b32 v201, 0xffff0000, v137
    v_mul_f32 v200, v199, v200
    v_mul_f32 v201, v199, v201
    v_cvt_pk_bf16_f32 v137, v200, v201
    v_lshlrev_b32 v200, 16, v138
    v_and_b32 v201, 0xffff0000, v138
    v_mul_f32 v200, v199, v200
    v_mul_f32 v201, v199, v201
    v_cvt_pk_bf16_f32 v138, v200, v201
    v_lshlrev_b32 v200, 16, v139
    v_and_b32 v201, 0xffff0000, v139
    v_mul_f32 v200, v199, v200
    v_mul_f32 v201, v199, v201
    v_cvt_pk_bf16_f32 v139, v200, v201
    v_lshlrev_b32 v200, 16, v140
    v_and_b32 v201, 0xffff0000, v140
    v_mul_f32 v200, v199, v200
    v_mul_f32 v201, v199, v201
    v_cvt_pk_bf16_f32 v140, v200, v201
    v_lshlrev_b32 v200, 16, v141
    v_and_b32 v201, 0xffff0000, v141
    v_mul_f32 v200, v199, v200
    v_mul_f32 v201, v199, v201
    v_cvt_pk_bf16_f32 v141, v200, v201
    v_lshlrev_b32 v200, 16, v142
    v_and_b32 v201, 0xffff0000, v142
    v_mul_f32 v200, v199, v200
    v_mul_f32 v201, v199, v201
    v_cvt_pk_bf16_f32 v142, v200, v201
    v_lshlrev_b32 v200, 16, v143
    v_and_b32 v201, 0xffff0000, v143
    v_mul_f32 v200, v199, v200
    v_mul_f32 v201, v199, v201
    v_cvt_pk_bf16_f32 v143, v200, v201
    s_nop 1
    s_setpc_b64 s[40:41]
L_rsc1:
    s_nop 15
    v_mov_b32 v198, v197
    s_nop 1
    v_permlane32_swap_b32 v198, v197
    v_max3_f32 v197, v198, v197, 0
    v_exp_f32 v199, -v197
    v_sub_f32 v96, v96, v197
    v_sub_f32 v97, v97, v197
    v_sub_f32 v98, v98, v197
    v_sub_f32 v99, v99, v197
    v_sub_f32 v100, v100, v197
    v_sub_f32 v101, v101, v197
    v_sub_f32 v102, v102, v197
    v_sub_f32 v103, v103, v197
    v_sub_f32 v104, v104, v197
    v_sub_f32 v105, v105, v197
    v_sub_f32 v106, v106, v197
    v_sub_f32 v107, v107, v197
    v_sub_f32 v108, v108, v197
    v_sub_f32 v109, v109, v197
    v_sub_f32 v110, v110, v197
    v_sub_f32 v111, v111, v197
    v_sub_f32 v112, v112, v197
    v_sub_f32 v113, v113, v197
    v_sub_f32 v114, v114, v197
    v_sub_f32 v115, v115, v197
    v_sub_f32 v116, v116, v197
    v_sub_f32 v117, v117, v197
    v_sub_f32 v118, v118, v197
    v_sub_f32 v119, v119, v197
    v_sub_f32 v120, v120, v197
    v_sub_f32 v121, v121, v197
    v_sub_f32 v122, v122, v197
    v_sub_f32 v123, v123, v197
    v_sub_f32 v124, v124, v197
    v_sub_f32 v125, v125, v197
    v_sub_f32 v126, v126, v197
    v_sub_f32 v127, v127, v197
    v_mul_f32 v196, v199, v196
    v_mul_f32 v16, v199, v16
    v_mul_f32 v17, v199, v17
    v_mul_f32 v18, v199, v18
    v_mul_f32 v19, v199, v19
    v_mul_f32 v20, v199, v20
    v_mul_f32 v21, v199, v21
    v_mul_f32 v22, v199, v22
    v_mul_f32 v23, v199, v23
    v_mul_f32 v24, v199, v24
    v_mul_f32 v25, v199, v25
    v_mul_f32 v26, v199, v26
    v_mul_f32 v27, v199, v27
    v_mul_f32 v28, v199, v28
    v_mul_f32 v29, v199, v29
    v_mul_f32 v30, v199, v30
    v_mul_f32 v31, v199, v31
    v_mul_f32 v32, v199, v32
    v_mul_f32 v33, v199, v33
    v_mul_f32 v34, v199, v34
    v_mul_f32 v35, v199, v35
    v_mul_f32 v36, v199, v36
    v_mul_f32 v37, v199, v37
    v_mul_f32 v38, v199, v38
    v_mul_f32 v39, v199, v39
    v_mul_f32 v40, v199, v40
    v_mul_f32 v41, v199, v41
    v_mul_f32 v42, v199, v42
    v_mul_f32 v43, v199, v43
    v_mul_f32 v44, v199, v44
    v_mul_f32 v45, v199, v45
    v_mul_f32 v46, v199, v46
    v_mul_f32 v47, v199, v47
    v_mul_f32 v48, v199, v48
    v_mul_f32 v49, v199, v49
    v_mul_f32 v50, v199, v50
    v_mul_f32 v51, v199, v51
    v_mul_f32 v52, v199, v52
    v_mul_f32 v53, v199, v53
    v_mul_f32 v54, v199, v54
    v_mul_f32 v55, v199, v55
    v_mul_f32 v56, v199, v56
    v_mul_f32 v57, v199, v57
    v_mul_f32 v58, v199, v58
    v_mul_f32 v59, v199, v59
    v_mul_f32 v60, v199, v60
    v_mul_f32 v61, v199, v61
    v_mul_f32 v62, v199, v62
    v_mul_f32 v63, v199, v63
    v_mul_f32 v64, v199, v64
    v_mul_f32 v65, v199, v65
    v_mul_f32 v66, v199, v66
    v_mul_f32 v67, v199, v67
    v_mul_f32 v68, v199, v68
    v_mul_f32 v69, v199, v69
    v_mul_f32 v70, v199, v70
    v_mul_f32 v71, v199, v71
    v_mul_f32 v72, v199, v72
    v_mul_f32 v73, v199, v73
    v_mul_f32 v74, v199, v74
    v_mul_f32 v75, v199, v75
    v_mul_f32 v76, v199, v76
    v_mul_f32 v77, v199, v77
    v_mul_f32 v78, v199, v78
    v_mul_f32 v79, v199, v79
    v_lshlrev_b32 v200, 16, v128
    v_and_b32 v201, 0xffff0000, v128
    v_mul_f32 v200, v199, v200
    v_mul_f32 v201, v199, v201
    v_cvt_pk_bf16_f32 v128, v200, v201
    v_lshlrev_b32 v200, 16, v129
    v_and_b32 v201, 0xffff0000, v129
    v_mul_f32 v200, v199, v200
    v_mul_f32 v201, v199, v201
    v_cvt_pk_bf16_f32 v129, v200, v201
    v_lshlrev_b32 v200, 16, v130
    v_and_b32 v201, 0xffff0000, v130
    v_mul_f32 v200, v199, v200
    v_mul_f32 v201, v199, v201
    v_cvt_pk_bf16_f32 v130, v200, v201
    v_lshlrev_b32 v200, 16, v131
    v_and_b32 v201, 0xffff0000, v131
    v_mul_f32 v200, v199, v200
    v_mul_f32 v201, v199, v201
    v_cvt_pk_bf16_f32 v131, v200, v201
    v_lshlrev_b32 v200, 16, v132
    v_and_b32 v201, 0xffff0000, v132
    v_mul_f32 v200, v199, v200
    v_mul_f32 v201, v199, v201
    v_cvt_pk_bf16_f32 v132, v200, v201
    v_lshlrev_b32 v200, 16, v133
    v_and_b32 v201, 0xffff0000, v133
    v_mul_f32 v200, v199, v200
    v_mul_f32 v201, v199, v201
    v_cvt_pk_bf16_f32 v133, v200, v201
    v_lshlrev_b32 v200, 16, v134
    v_and_b32 v201, 0xffff0000, v134
    v_mul_f32 v200, v199, v200
    v_mul_f32 v201, v199, v201
    v_cvt_pk_bf16_f32 v134, v200, v201
    v_lshlrev_b32 v200, 16, v135
    v_and_b32 v201, 0xffff0000, v135
    v_mul_f32 v200, v199, v200
    v_mul_f32 v201, v199, v201
    v_cvt_pk_bf16_f32 v135, v200, v201
    s_nop 1
    s_setpc_b64 s[40:41]
L_codeend:
    s_endpgm
.section .rodata,"a"
.p2align 6
.amdhsa_kernel standalone__gqa_block_cached__near_ridge_kernel
  .amdhsa_next_free_vgpr 512
  .amdhsa_next_free_sgpr 102
  .amdhsa_accum_offset 256
  .amdhsa_group_segment_fixed_size 0
  .amdhsa_kernarg_size 64
  .amdhsa_user_sgpr_count 2
  .amdhsa_user_sgpr_kernarg_segment_ptr 1
  .amdhsa_system_sgpr_workgroup_id_x 1
.end_amdhsa_kernel
```
